```python
import torch

def _softmax(x, axis=-1):
    return torch.softmax(x, dim=axis)
def _gelu(x):
    return torch.nn.functional.gelu(x, approximate="tanh")
def _silu(x):
    return torch.nn.functional.silu(x)
def _sigmoid(x):
    return torch.sigmoid(x)
def _layernorm(x, axis=-1, eps=1e-5):
    m = x.mean(dim=axis, keepdim=True)
    v = x.var(dim=axis, keepdim=True, unbiased=False)
    return (x - m) / torch.sqrt(v + eps)
def _scatter_add(tgt, idx, src, axis=0):
    return tgt.clone().index_add_(axis, idx, src)
def _segment_sum(src, seg, n):
    out = torch.zeros((n,) + src.shape[1:], dtype=src.dtype)
    return out.index_add_(0, seg, src)
def _pad(x, pw):
    flat = tuple(v for pair in reversed(pw) for v in pair)
    return torch.nn.functional.pad(x, flat)

kernel_name = 'standalone__mpnn_edge_mlp__graph'

def setup_inputs():

    _w = (lambda a: (lambda t: t.to(torch.bfloat16) if t.is_floating_point() else t)(torch.as_tensor(a)))
    N, deg, D, De = 50000, 16, 64, max(0, 1)
    E = N * deg
    return {
        "x": _w((lambda *s: torch.randn(*s, dtype=torch.bfloat16) * 0.05)(N, D)),
        "e_attr": _w((lambda *s: torch.randn(*s, dtype=torch.bfloat16) * 0.8)(E, De)),
        "src": _w((lambda lo, hi, *s: torch.randint(lo, hi, s))(0, N, E).to(torch.int64)),
        "dst": _w((lambda lo, hi, *s: torch.randint(lo, hi, s))(0, N, E).to(torch.int64)),
        "w_msg": _w((lambda *s: torch.randn(*s, dtype=torch.bfloat16) * 0.8)(2 * D + De, D)),
        "w_upd": _w((lambda *s: torch.randn(*s, dtype=torch.bfloat16) * 0.05)(2 * D, D)),
    }

def reference(x, e_attr, src, dst, w_msg, w_upd):
    N, D = x.shape
    m_in = torch.concatenate([x[src], x[dst], e_attr], axis=-1)
    msg = _silu(m_in @ w_msg)
    agg = _segment_sum(msg, dst, N)
    return _silu(torch.concatenate([x, agg], axis=-1) @ w_upd)
```

```asm
; @launch kernel=k1_kernel grid=(249,1,1) block=(832,1,1) lds=69648
; @launch kernel=k2_kernel grid=(256,1,1) block=(1024,1,1) lds=163840
.amdgcn_target "amdgcn-amd-amdhsa--gfx950"
.text
.globl k1_kernel
.p2align 8
.type k1_kernel,@function
k1_kernel:
    s_cmp_ge_u32 s2, 249
    s_cbranch_scc1 K1_END
    s_load_dwordx4 s[4:7], s[0:1], 0
    s_load_dwordx4 s[8:11], s[0:1], 16
    s_load_dwordx4 s[12:15], s[0:1], 32
    s_load_dwordx2 s[16:17], s[0:1], 64
    s_cmp_ge_u32 s2, 125
    s_cbranch_scc1 K1_OTHER
    s_mul_i32 s3, s2, 25600
    v_lshl_add_u32 v1, v0, 4, s3
    s_mul_i32 s18, s2, 12800
    v_lshl_add_u32 v2, v0, 3, s18
    v_lshlrev_b32 v3, 2, v0
    v_mov_b32 v44, 0
    s_movk_i32 s42, 12800
    s_movk_i32 s43, 6400
    v_cmp_gt_u32 vcc, 320, v0
    s_and_saveexec_b64 s[40:41], vcc
    ds_write_b32 v3, v44
    s_mov_b64 exec, s[40:41]
    v_cmp_gt_u32 vcc, 800, v0
    s_waitcnt lgkmcnt(0)
    s_mov_b32 s32, s10
    s_and_b32 s33, s11, 0xffff
    s_mov_b32 s34, 3200000
    s_mov_b32 s35, 0x20000
    s_mov_b32 s28, s8
    s_and_b32 s29, s9, 0xffff
    s_mov_b32 s30, 3200000
    s_mov_b32 s31, 0x20000
    s_mov_b32 s24, s6
    s_and_b32 s25, s7, 0xffff
    s_mov_b32 s26, 1600000
    s_mov_b32 s27, 0x20000
    s_mov_b64 s[40:41], exec
    s_and_b64 exec, exec, vcc
    s_mov_b64 s[44:45], exec
    buffer_load_dwordx4 v[4:7], v1, s[32:35], 0 offen
    buffer_load_dwordx4 v[8:11], v1, s[32:35], s42 offen
    buffer_load_dwordx4 v[12:15], v1, s[28:31], 0 offen
    buffer_load_dwordx4 v[16:19], v1, s[28:31], s42 offen
    buffer_load_dwordx2 v[20:21], v2, s[24:27], 0 offen
    buffer_load_dwordx2 v[22:23], v2, s[24:27], s43 offen
    s_mov_b32 s36, s16
    s_and_b32 s37, s17, 0xffff
    s_mov_b32 s38, 4587520
    s_mov_b32 s39, 0x20000
    v_mov_b32 v45, 1
    s_barrier
    s_waitcnt vmcnt(4)
    v_mul_u32_u24 v24, 85599, v4
    v_mul_u32_u24 v25, 85599, v5
    v_mul_u32_u24 v26, 85599, v6
    v_mul_u32_u24 v27, 85599, v7
    v_mul_u32_u24 v28, 85599, v8
    v_mul_u32_u24 v29, 85599, v9
    v_mul_u32_u24 v30, 85599, v10
    v_mul_u32_u24 v31, 85599, v11
    v_lshrrev_b32 v24, 22, v24
    v_lshrrev_b32 v25, 22, v25
    v_lshrrev_b32 v26, 22, v26
    v_lshrrev_b32 v27, 22, v27
    v_lshrrev_b32 v28, 22, v28
    v_lshrrev_b32 v29, 22, v29
    v_lshrrev_b32 v30, 22, v30
    v_lshrrev_b32 v31, 22, v31
    v_and_b32 v24, 0x3fc, v24
    v_and_b32 v25, 0x3fc, v25
    v_and_b32 v26, 0x3fc, v26
    v_and_b32 v27, 0x3fc, v27
    v_and_b32 v28, 0x3fc, v28
    v_and_b32 v29, 0x3fc, v29
    v_and_b32 v30, 0x3fc, v30
    v_and_b32 v31, 0x3fc, v31
    v_mov_b32 v46, -49
    ds_add_rtn_u32 v32, v24, v45 offset:0
    v_mad_i32_i24 v4, v24, v46, v4
    ds_add_rtn_u32 v33, v25, v45 offset:0
    v_mad_i32_i24 v5, v25, v46, v5
    ds_add_rtn_u32 v34, v26, v45 offset:0
    v_mad_i32_i24 v6, v26, v46, v6
    ds_add_rtn_u32 v35, v27, v45 offset:0
    v_mad_i32_i24 v7, v27, v46, v7
    ds_add_rtn_u32 v36, v28, v45 offset:0
    v_mad_i32_i24 v8, v28, v46, v8
    ds_add_rtn_u32 v37, v29, v45 offset:0
    v_mad_i32_i24 v9, v29, v46, v9
    ds_add_rtn_u32 v38, v30, v45 offset:0
    v_mad_i32_i24 v10, v30, v46, v10
    ds_add_rtn_u32 v39, v31, v45 offset:0
    v_mad_i32_i24 v11, v31, v46, v11
    s_waitcnt vmcnt(0)
    v_mov_b32 v47, 0xffff0000
    v_lshl_or_b32 v12, v20, 16, v12
    v_and_or_b32 v13, v20, v47, v13
    v_lshl_or_b32 v14, v21, 16, v14
    v_and_or_b32 v15, v21, v47, v15
    v_lshl_or_b32 v16, v22, 16, v16
    v_and_or_b32 v17, v22, v47, v17
    v_lshl_or_b32 v18, v23, 16, v18
    v_and_or_b32 v19, v23, v47, v19
    v_and_b32 v20, 0x7fff7fff, v20
    v_and_b32 v21, 0x7fff7fff, v21
    v_and_b32 v22, 0x7fff7fff, v22
    v_and_b32 v23, 0x7fff7fff, v23
    v_pk_max_u16 v20, v20, v21
    v_pk_max_u16 v22, v22, v23
    v_pk_max_u16 v20, v20, v22
    v_lshlrev_b32 v21, 16, v20
    v_and_b32 v20, v47, v20
    v_max_u32 v20, v20, v21
    v_and_b32 v21, 63, v0
    v_lshlrev_b32 v21, 2, v21
    ds_max_u32 v21, v20 offset:1024
    s_mov_b64 exec, s[40:41]
    v_and_b32 v47, 63, v0
    v_lshlrev_b32 v48, 4, v47
    s_waitcnt lgkmcnt(0)
    s_barrier
    ds_read_b128 v[40:43], v48 offset:0
    s_waitcnt lgkmcnt(0)
    v_add_u32 v49, v40, v41
    v_add_u32 v50, v42, v43
    v_add_u32 v49, v49, v50
    v_mov_b32 v50, v49
    s_nop 1
    v_add_u32_dpp v50, v50, v50 row_shr:1 row_mask:0xf bank_mask:0xf
    s_nop 1
    v_add_u32_dpp v50, v50, v50 row_shr:2 row_mask:0xf bank_mask:0xf
    s_nop 1
    v_add_u32_dpp v50, v50, v50 row_shr:4 row_mask:0xf bank_mask:0xf
    s_nop 1
    v_add_u32_dpp v50, v50, v50 row_shr:8 row_mask:0xf bank_mask:0xf
    s_nop 1
    v_add_u32_dpp v50, v50, v50 row_bcast:15 row_mask:0xa bank_mask:0xf
    s_nop 1
    v_add_u32_dpp v50, v50, v50 row_bcast:31 row_mask:0xc bank_mask:0xf
    v_sub_u32 v52, v50, v49
    v_add_u32 v53, v52, v40
    v_add_u32 v54, v53, v41
    v_add_u32 v55, v54, v42
    ds_write_b128 v48, v[52:55] offset:1280
    v_readfirstlane_b32 s3, v0
    s_nop 0
    s_cmp_lt_u32 s3, 64
    s_cbranch_scc0 K1_NOCELL
    v_lshl_or_b32 v56, v40, 16, v52
    v_lshl_or_b32 v57, v41, 16, v53
    v_lshl_or_b32 v58, v42, 16, v54
    v_lshl_or_b32 v59, v43, 16, v55
    s_lshl_b32 s3, s2, 10
    s_add_u32 s3, s3, 4194304
    buffer_store_dwordx4 v[56:59], v48, s[36:39], s3 offen
    v_lshlrev_b32 v60, 2, v47
    ds_read_b32 v60, v60 offset:1024
    s_waitcnt lgkmcnt(0)
    s_nop 1
    v_max_u32_dpp v60, v60, v60 row_shr:1 row_mask:0xf bank_mask:0xf
    s_nop 1
    v_max_u32_dpp v60, v60, v60 row_shr:2 row_mask:0xf bank_mask:0xf
    s_nop 1
    v_max_u32_dpp v60, v60, v60 row_shr:4 row_mask:0xf bank_mask:0xf
    s_nop 1
    v_max_u32_dpp v60, v60, v60 row_shr:8 row_mask:0xf bank_mask:0xf
    s_nop 1
    v_max_u32_dpp v60, v60, v60 row_bcast:15 row_mask:0xa bank_mask:0xf
    s_nop 1
    v_max_u32_dpp v60, v60, v60 row_bcast:31 row_mask:0xc bank_mask:0xf
    s_lshl_b32 s3, s2, 2
    s_add_u32 s3, s3, 4456448
    v_mov_b32 v61, 0
    s_mov_b32 exec_lo, 0
    s_mov_b32 exec_hi, 0x80000000
    buffer_store_dword v60, v61, s[36:39], s3 offen
K1_NOCELL:
    s_mov_b64 exec, s[44:45]
    s_waitcnt lgkmcnt(0)
    ds_read_b32 v24, v24 offset:1280
    ds_read_b32 v25, v25 offset:1280
    ds_read_b32 v26, v26 offset:1280
    ds_read_b32 v27, v27 offset:1280
    ds_read_b32 v28, v28 offset:1280
    ds_read_b32 v29, v29 offset:1280
    ds_read_b32 v30, v30 offset:1280
    ds_read_b32 v31, v31 offset:1280
    s_waitcnt lgkmcnt(0)
    v_add_u32 v24, v24, v32
    v_add_u32 v25, v25, v33
    v_add_u32 v26, v26, v34
    v_add_u32 v27, v27, v35
    v_add_u32 v28, v28, v36
    v_add_u32 v29, v29, v37
    v_add_u32 v30, v30, v38
    v_add_u32 v31, v31, v39
    ds_write_b8 v24, v4 offset:27904
    v_lshlrev_b32 v32, 2, v24
    ds_write_b8 v25, v5 offset:27904
    v_lshlrev_b32 v33, 2, v25
    ds_write_b8 v26, v6 offset:27904
    v_lshlrev_b32 v34, 2, v26
    ds_write_b8 v27, v7 offset:27904
    v_lshlrev_b32 v35, 2, v27
    ds_write_b8 v28, v8 offset:27904
    v_lshlrev_b32 v36, 2, v28
    ds_write_b8 v29, v9 offset:27904
    v_lshlrev_b32 v37, 2, v29
    ds_write_b8 v30, v10 offset:27904
    v_lshlrev_b32 v38, 2, v30
    ds_write_b8 v31, v11 offset:27904
    v_lshlrev_b32 v39, 2, v31
    ds_write_b32 v32, v12 offset:2304
    ds_write_b32 v33, v13 offset:2304
    ds_write_b32 v34, v14 offset:2304
    ds_write_b32 v35, v15 offset:2304
    ds_write_b32 v36, v16 offset:2304
    ds_write_b32 v37, v17 offset:2304
    ds_write_b32 v38, v18 offset:2304
    ds_write_b32 v39, v19 offset:2304
    v_lshlrev_b32 v3, 4, v0
    s_mul_i32 s3, s2, 25600
    s_add_u32 s18, s3, 12800
    s_waitcnt lgkmcnt(0)
    s_barrier
    ds_read_b128 v[4:7], v3 offset:2304
    ds_read_b128 v[8:11], v3 offset:15104
    v_cmp_gt_u32 vcc, 400, v0
    s_waitcnt lgkmcnt(1)
    buffer_store_dwordx4 v[4:7], v3, s[36:39], s3 offen sc1
    s_waitcnt lgkmcnt(0)
    buffer_store_dwordx4 v[8:11], v3, s[36:39], s18 offen sc1
    s_and_b64 exec, exec, vcc
    s_cbranch_execz K1_END
    ds_read_b128 v[12:15], v3 offset:27904
    s_mul_i32 s3, s2, 6400
    s_add_u32 s3, s3, 3276800
    s_waitcnt lgkmcnt(0)
    buffer_store_dwordx4 v[12:15], v3, s[36:39], s3 offen sc1
    s_endpgm
K1_OTHER:
    v_lshrrev_b32 v1, 6, v0
    v_and_b32 v2, 63, v0
    s_nop 0
    v_readfirstlane_b32 s3, v1
    s_cmp_ge_u32 s2, 246
    s_cbranch_scc1 K1_WEIGHTS
    s_sub_u32 s18, s2, 125
    s_mul_i32 s18, s18, 13
    s_add_u32 s18, s18, s3
    s_lshl_b32 s19, s18, 12
    s_lshl_b32 s43, s3, 12
    s_add_u32 s43, s43, 16384
    v_lshrrev_b32 v3, 4, v2
    v_and_b32 v4, 7, v2
    v_xor_b32 v3, v3, v4
    v_lshlrev_b32 v3, 4, v3
    v_lshrrev_b32 v4, 3, v2
    v_lshl_add_u32 v3, v4, 7, v3
    v_xor_b32 v4, 64, v3
    v_lshlrev_b32 v6, 4, v0
    s_waitcnt lgkmcnt(0)
    s_mov_b32 s20, s4
    s_and_b32 s21, s5, 0xffff
    s_mov_b32 s22, 6400000
    s_mov_b32 s23, 0x20000
    s_mov_b32 s24, s12
    s_and_b32 s25, s13, 0xffff
    s_mov_b32 s26, 16384
    s_mov_b32 s27, 0x20000
    s_movk_i32 s42, 13312
    buffer_load_dwordx4 v[8:11], v6, s[24:27], 0 offen
    buffer_load_dwordx4 v[12:15], v6, s[24:27], s42 offen
    s_mov_b32 m0, s43
    s_nop 0
    buffer_load_dwordx4 v3, s[20:23], s19 offen lds
    s_add_u32 m0, m0, 1024
    s_add_u32 s19, s19, 1024
    buffer_load_dwordx4 v4, s[20:23], s19 offen lds
    s_add_u32 m0, m0, 1024
    s_add_u32 s19, s19, 1024
    buffer_load_dwordx4 v3, s[20:23], s19 offen lds
    s_add_u32 m0, m0, 1024
    s_add_u32 s19, s19, 1024
    buffer_load_dwordx4 v4, s[20:23], s19 offen lds
    s_sub_u32 s19, s19, 3072
    s_add_u32 s28, s16, 5242880
    s_addc_u32 s29, s17, 0
    s_and_b32 s29, s29, 0xffff
    s_mov_b32 s30, 6400000
    s_mov_b32 s31, 0x20000
    s_mov_b32 s36, s16
    s_and_b32 s37, s17, 0xffff
    s_mov_b32 s38, 4587520
    s_mov_b32 s39, 0x20000
    v_and_b32 v16, 31, v2
    v_lshrrev_b32 v17, 5, v2
    v_bfe_u32 v7, v2, 2, 2
    v_lshl_add_u32 v7, v17, 3, v7
    v_lshlrev_b32 v7, 7, v7
    v_and_b32 v18, 1, v2
    v_lshl_add_u32 v7, v18, 5, v7
    v_bfe_u32 v18, v2, 4, 1
    v_lshl_add_u32 v7, v18, 4, v7
    v_bfe_u32 v18, v2, 1, 1
    v_lshl_add_u32 v7, v18, 3, v7
    v_bfe_u32 v18, v16, 1, 3
    v_xor_b32 v18, v18, v17
    v_lshlrev_b32 v18, 4, v18
    v_lshl_add_u32 v19, v16, 7, s43
    v_mov_b32 v24, 69632
    v_mov_b32 v26, 0
    v_mov_b32 v27, 0
    ds_write_b64 v24, v[26:27]
    v_cmp_gt_u32 vcc, 192, v0
    s_waitcnt vmcnt(5)
    ds_write_b128 v6, v[8:11]
    s_and_b64 exec, exec, vcc
    s_waitcnt vmcnt(4)
    ds_write_b128 v6, v[12:15] offset:13312
    s_mov_b64 exec, -1
    v_xor_b32 v20, 0, v18
    v_add_u32 v20, v19, v20
    v_xor_b32 v21, 32, v18
    v_add_u32 v21, v19, v21
    v_xor_b32 v22, 64, v18
    v_add_u32 v22, v19, v22
    v_xor_b32 v23, 96, v18
    v_add_u32 v23, v19, v23
    s_waitcnt lgkmcnt(0)
    s_barrier
    ds_read_b64_tr_b16 v[48:49], v7 offset:0
    ds_read_b64_tr_b16 v[50:51], v7 offset:512
    ds_read_b64_tr_b16 v[52:53], v7 offset:2048
    ds_read_b64_tr_b16 v[54:55], v7 offset:2560
    ds_read_b64_tr_b16 v[56:57], v7 offset:4096
    ds_read_b64_tr_b16 v[58:59], v7 offset:4608
    ds_read_b64_tr_b16 v[60:61], v7 offset:6144
    ds_read_b64_tr_b16 v[62:63], v7 offset:6656
    ds_read_b64_tr_b16 v[64:65], v7 offset:64
    ds_read_b64_tr_b16 v[66:67], v7 offset:576
    ds_read_b64_tr_b16 v[68:69], v7 offset:2112
    ds_read_b64_tr_b16 v[70:71], v7 offset:2624
    ds_read_b64_tr_b16 v[72:73], v7 offset:4160
    ds_read_b64_tr_b16 v[74:75], v7 offset:4672
    ds_read_b64_tr_b16 v[76:77], v7 offset:6208
    ds_read_b64_tr_b16 v[78:79], v7 offset:6720
    s_waitcnt vmcnt(0)
    ds_read_b128 v[32:35], v20
    ds_read_b128 v[36:39], v21
    ds_read_b128 v[40:43], v22
    ds_read_b128 v[44:47], v23
    v_mov_b32 v8, 0xbfb8aa3b
    v_mov_b32 v9, 0
    v_and_b32 v10, 7, v16
    v_lshlrev_b32 v11, 1, v17
    v_xor_b32 v10, v10, v11
    v_lshlrev_b32 v10, 4, v10
    v_add_u32 v10, v19, v10
    v_lshrrev_b32 v11, 3, v2
    v_and_b32 v12, 7, v2
    v_xor_b32 v12, v12, v11
    v_lshlrev_b32 v12, 4, v12
    v_lshl_add_u32 v12, v11, 7, v12
    v_add_u32 v12, s43, v12
    v_lshlrev_b32 v13, 4, v2
    v_mov_b32 v16, v8
    v_mov_b32 v17, v8
    s_add_u32 s44, s16, 11665408
    s_addc_u32 s45, s17, 0
    s_and_b32 s45, s45, 0xffff
    s_mov_b32 s46, 6400000
    s_mov_b32 s47, 0x20000
    s_waitcnt lgkmcnt(0)
    v_mfma_f32_32x32x16_bf16 v[80:95], v[48:51], v[32:35], 0
    v_mfma_f32_32x32x16_bf16 v[80:95], v[52:55], v[36:39], v[80:95]
    v_mfma_f32_32x32x16_bf16 v[80:95], v[56:59], v[40:43], v[80:95]
    v_mfma_f32_32x32x16_bf16 v[80:95], v[60:63], v[44:47], v[80:95]
    v_mfma_f32_32x32x16_bf16 v[96:111], v[64:67], v[32:35], 0
    v_mfma_f32_32x32x16_bf16 v[96:111], v[68:71], v[36:39], v[96:111]
    v_mfma_f32_32x32x16_bf16 v[96:111], v[72:75], v[40:43], v[96:111]
    v_mfma_f32_32x32x16_bf16 v[96:111], v[76:79], v[44:47], v[96:111]
    ds_read_b64_tr_b16 v[48:49], v7 offset:8192
    ds_read_b64_tr_b16 v[50:51], v7 offset:8704
    ds_read_b64_tr_b16 v[52:53], v7 offset:10240
    ds_read_b64_tr_b16 v[54:55], v7 offset:10752
    ds_read_b64_tr_b16 v[56:57], v7 offset:12288
    ds_read_b64_tr_b16 v[58:59], v7 offset:12800
    ds_read_b64_tr_b16 v[60:61], v7 offset:14336
    ds_read_b64_tr_b16 v[62:63], v7 offset:14848
    ds_read_b64_tr_b16 v[64:65], v7 offset:8256
    ds_read_b64_tr_b16 v[66:67], v7 offset:8768
    ds_read_b64_tr_b16 v[68:69], v7 offset:10304
    ds_read_b64_tr_b16 v[70:71], v7 offset:10816
    ds_read_b64_tr_b16 v[72:73], v7 offset:12352
    ds_read_b64_tr_b16 v[74:75], v7 offset:12864
    ds_read_b64_tr_b16 v[76:77], v7 offset:14400
    ds_read_b64_tr_b16 v[78:79], v7 offset:14912
    v_pk_mul_f32 v[80:81], v[80:81], v[16:17]
    v_pk_mul_f32 v[82:83], v[82:83], v[16:17]
    v_pk_mul_f32 v[84:85], v[84:85], v[16:17]
    v_pk_mul_f32 v[86:87], v[86:87], v[16:17]
    v_pk_mul_f32 v[88:89], v[88:89], v[16:17]
    v_pk_mul_f32 v[90:91], v[90:91], v[16:17]
    v_pk_mul_f32 v[92:93], v[92:93], v[16:17]
    v_pk_mul_f32 v[94:95], v[94:95], v[16:17]
    v_maximum3_f32 v9, |v80|, |v81|, v9
    v_maximum3_f32 v9, |v82|, |v83|, v9
    v_maximum3_f32 v9, |v84|, |v85|, v9
    v_maximum3_f32 v9, |v86|, |v87|, v9
    v_maximum3_f32 v9, |v88|, |v89|, v9
    v_maximum3_f32 v9, |v90|, |v91|, v9
    v_maximum3_f32 v9, |v92|, |v93|, v9
    v_maximum3_f32 v9, |v94|, |v95|, v9
    v_cvt_pk_f16_f32 v112, v80, v81
    v_cvt_pk_f16_f32 v113, v82, v83
    v_cvt_pk_f16_f32 v114, v84, v85
    v_cvt_pk_f16_f32 v115, v86, v87
    v_cvt_pk_f16_f32 v116, v88, v89
    v_cvt_pk_f16_f32 v117, v90, v91
    v_cvt_pk_f16_f32 v118, v92, v93
    v_cvt_pk_f16_f32 v119, v94, v95
    v_pk_mul_f32 v[96:97], v[96:97], v[16:17]
    v_pk_mul_f32 v[98:99], v[98:99], v[16:17]
    v_pk_mul_f32 v[100:101], v[100:101], v[16:17]
    v_pk_mul_f32 v[102:103], v[102:103], v[16:17]
    v_pk_mul_f32 v[104:105], v[104:105], v[16:17]
    v_pk_mul_f32 v[106:107], v[106:107], v[16:17]
    v_pk_mul_f32 v[108:109], v[108:109], v[16:17]
    v_pk_mul_f32 v[110:111], v[110:111], v[16:17]
    v_maximum3_f32 v9, |v96|, |v97|, v9
    v_maximum3_f32 v9, |v98|, |v99|, v9
    v_maximum3_f32 v9, |v100|, |v101|, v9
    v_maximum3_f32 v9, |v102|, |v103|, v9
    v_maximum3_f32 v9, |v104|, |v105|, v9
    v_maximum3_f32 v9, |v106|, |v107|, v9
    v_maximum3_f32 v9, |v108|, |v109|, v9
    v_maximum3_f32 v9, |v110|, |v111|, v9
    v_cvt_pk_f16_f32 v120, v96, v97
    v_cvt_pk_f16_f32 v121, v98, v99
    v_cvt_pk_f16_f32 v122, v100, v101
    v_cvt_pk_f16_f32 v123, v102, v103
    v_cvt_pk_f16_f32 v124, v104, v105
    v_cvt_pk_f16_f32 v125, v106, v107
    v_cvt_pk_f16_f32 v126, v108, v109
    v_cvt_pk_f16_f32 v127, v110, v111
    s_waitcnt lgkmcnt(0)
    v_mfma_f32_32x32x16_bf16 v[80:95], v[48:51], v[32:35], 0
    v_mfma_f32_32x32x16_bf16 v[80:95], v[52:55], v[36:39], v[80:95]
    v_mfma_f32_32x32x16_bf16 v[80:95], v[56:59], v[40:43], v[80:95]
    v_mfma_f32_32x32x16_bf16 v[80:95], v[60:63], v[44:47], v[80:95]
    v_mfma_f32_32x32x16_bf16 v[96:111], v[64:67], v[32:35], 0
    v_mfma_f32_32x32x16_bf16 v[96:111], v[68:71], v[36:39], v[96:111]
    v_mfma_f32_32x32x16_bf16 v[96:111], v[72:75], v[40:43], v[96:111]
    v_mfma_f32_32x32x16_bf16 v[96:111], v[76:79], v[44:47], v[96:111]
    ds_write_b128 v10, v[112:115]
    v_xor_b32 v11, 16, v10
    ds_write_b128 v11, v[116:119]
    v_xor_b32 v11, 64, v10
    ds_write_b128 v11, v[120:123]
    v_xor_b32 v11, 80, v10
    ds_write_b128 v11, v[124:127]
    s_waitcnt lgkmcnt(0)
    ds_read_b128 v[32:35], v12 offset:0
    ds_read_b128 v[36:39], v12 offset:1024
    ds_read_b128 v[40:43], v12 offset:2048
    ds_read_b128 v[44:47], v12 offset:3072
    s_waitcnt lgkmcnt(3)
    buffer_store_dwordx4 v[32:35], v13, s[28:31], s19 offen offset:0 sc1
    s_waitcnt lgkmcnt(2)
    buffer_store_dwordx4 v[36:39], v13, s[28:31], s19 offen offset:1024 sc1
    s_waitcnt lgkmcnt(1)
    buffer_store_dwordx4 v[40:43], v13, s[28:31], s19 offen offset:2048 sc1
    s_waitcnt lgkmcnt(0)
    buffer_store_dwordx4 v[44:47], v13, s[28:31], s19 offen offset:3072 sc1
    v_mov_b32 v14, 0
    v_pk_mul_f32 v[80:81], v[80:81], v[16:17]
    v_pk_mul_f32 v[82:83], v[82:83], v[16:17]
    v_pk_mul_f32 v[84:85], v[84:85], v[16:17]
    v_pk_mul_f32 v[86:87], v[86:87], v[16:17]
    v_pk_mul_f32 v[88:89], v[88:89], v[16:17]
    v_pk_mul_f32 v[90:91], v[90:91], v[16:17]
    v_pk_mul_f32 v[92:93], v[92:93], v[16:17]
    v_pk_mul_f32 v[94:95], v[94:95], v[16:17]
    v_pk_mul_f32 v[96:97], v[96:97], v[16:17]
    v_pk_mul_f32 v[98:99], v[98:99], v[16:17]
    v_pk_mul_f32 v[100:101], v[100:101], v[16:17]
    v_pk_mul_f32 v[102:103], v[102:103], v[16:17]
    v_pk_mul_f32 v[104:105], v[104:105], v[16:17]
    v_pk_mul_f32 v[106:107], v[106:107], v[16:17]
    v_pk_mul_f32 v[108:109], v[108:109], v[16:17]
    v_pk_mul_f32 v[110:111], v[110:111], v[16:17]
    v_maximum3_f32 v14, |v80|, |v81|, v14
    v_maximum3_f32 v14, |v82|, |v83|, v14
    v_maximum3_f32 v14, |v84|, |v85|, v14
    v_maximum3_f32 v14, |v86|, |v87|, v14
    v_maximum3_f32 v14, |v88|, |v89|, v14
    v_maximum3_f32 v14, |v90|, |v91|, v14
    v_maximum3_f32 v14, |v92|, |v93|, v14
    v_maximum3_f32 v14, |v94|, |v95|, v14
    v_maximum3_f32 v14, |v96|, |v97|, v14
    v_maximum3_f32 v14, |v98|, |v99|, v14
    v_maximum3_f32 v14, |v100|, |v101|, v14
    v_maximum3_f32 v14, |v102|, |v103|, v14
    v_maximum3_f32 v14, |v104|, |v105|, v14
    v_maximum3_f32 v14, |v106|, |v107|, v14
    v_maximum3_f32 v14, |v108|, |v109|, v14
    v_maximum3_f32 v14, |v110|, |v111|, v14
    v_cvt_pk_f16_f32 v112, v80, v81
    v_cvt_pk_f16_f32 v113, v82, v83
    v_cvt_pk_f16_f32 v114, v84, v85
    v_cvt_pk_f16_f32 v115, v86, v87
    v_cvt_pk_f16_f32 v116, v88, v89
    v_cvt_pk_f16_f32 v117, v90, v91
    v_cvt_pk_f16_f32 v118, v92, v93
    v_cvt_pk_f16_f32 v119, v94, v95
    v_cvt_pk_f16_f32 v120, v96, v97
    v_cvt_pk_f16_f32 v121, v98, v99
    v_cvt_pk_f16_f32 v122, v100, v101
    v_cvt_pk_f16_f32 v123, v102, v103
    v_cvt_pk_f16_f32 v124, v104, v105
    v_cvt_pk_f16_f32 v125, v106, v107
    v_cvt_pk_f16_f32 v126, v108, v109
    v_cvt_pk_f16_f32 v127, v110, v111
    ds_write_b128 v10, v[112:115]
    v_xor_b32 v11, 16, v10
    ds_write_b128 v11, v[116:119]
    v_xor_b32 v11, 64, v10
    ds_write_b128 v11, v[120:123]
    v_xor_b32 v11, 80, v10
    ds_write_b128 v11, v[124:127]
    v_and_b32 v9, 0x7fffffff, v9
    v_and_b32 v14, 0x7fffffff, v14
    s_nop 0
    v_max_u32_dpp v9, v9, v9 row_shr:1 row_mask:0xf bank_mask:0xf
    v_max_u32_dpp v14, v14, v14 row_shr:1 row_mask:0xf bank_mask:0xf
    s_nop 0
    v_max_u32_dpp v9, v9, v9 row_shr:2 row_mask:0xf bank_mask:0xf
    v_max_u32_dpp v14, v14, v14 row_shr:2 row_mask:0xf bank_mask:0xf
    s_nop 0
    v_max_u32_dpp v9, v9, v9 row_shr:4 row_mask:0xf bank_mask:0xf
    v_max_u32_dpp v14, v14, v14 row_shr:4 row_mask:0xf bank_mask:0xf
    s_nop 0
    v_max_u32_dpp v9, v9, v9 row_shr:8 row_mask:0xf bank_mask:0xf
    v_max_u32_dpp v14, v14, v14 row_shr:8 row_mask:0xf bank_mask:0xf
    s_nop 0
    v_max_u32_dpp v9, v9, v9 row_bcast:15 row_mask:0xa bank_mask:0xf
    v_max_u32_dpp v14, v14, v14 row_bcast:15 row_mask:0xa bank_mask:0xf
    s_nop 0
    v_max_u32_dpp v9, v9, v9 row_bcast:31 row_mask:0xc bank_mask:0xf
    v_max_u32_dpp v14, v14, v14 row_bcast:31 row_mask:0xc bank_mask:0xf
    s_waitcnt lgkmcnt(0)
    ds_read_b128 v[32:35], v12 offset:0
    ds_read_b128 v[36:39], v12 offset:1024
    ds_read_b128 v[40:43], v12 offset:2048
    ds_read_b128 v[44:47], v12 offset:3072
    s_waitcnt lgkmcnt(3)
    buffer_store_dwordx4 v[32:35], v13, s[44:47], s19 offen offset:0 sc1
    s_waitcnt lgkmcnt(2)
    buffer_store_dwordx4 v[36:39], v13, s[44:47], s19 offen offset:1024 sc1
    s_waitcnt lgkmcnt(1)
    buffer_store_dwordx4 v[40:43], v13, s[44:47], s19 offen offset:2048 sc1
    s_waitcnt lgkmcnt(0)
    buffer_store_dwordx4 v[44:47], v13, s[44:47], s19 offen offset:3072 sc1
    s_mov_b32 exec_lo, 0
    s_mov_b32 exec_hi, 0x80000000
    ds_max_u32 v24, v9
    ds_max_u32 v24, v14 offset:4
    s_mov_b64 exec, -1
    s_waitcnt lgkmcnt(0)
    s_barrier
    s_cmp_eq_u32 s3, 0
    s_cbranch_scc0 K1_END
    ds_read_b64 v[26:27], v24
    s_sub_u32 s3, s2, 125
    s_lshl_b32 s3, s3, 2
    s_add_u32 s3, s3, 4456960
    v_mov_b32 v10, 0
    s_mov_b64 exec, 1
    s_waitcnt lgkmcnt(0)
    buffer_store_dword v26, v10, s[36:39], s3 offen
    buffer_store_dword v27, v10, s[36:39], s3 offen offset:512
    s_endpgm
K1_WEIGHTS:
    s_sub_u32 s18, s2, 246
    s_mul_i32 s18, s18, 13
    s_add_u32 s18, s18, s3
    s_waitcnt lgkmcnt(0)
    s_mov_b32 s20, s12
    s_and_b32 s21, s13, 0xffff
    s_mov_b32 s22, 16512
    s_mov_b32 s23, 0x20000
    s_mov_b32 s24, s14
    s_and_b32 s25, s15, 0xffff
    s_mov_b32 s26, 16384
    s_mov_b32 s27, 0x20000
    s_add_u32 s36, s16, 4521984
    s_addc_u32 s37, s17, 0
    s_and_b32 s37, s37, 0xffff
    s_mov_b32 s38, 45056
    s_mov_b32 s39, 0x20000
    v_and_b32 v3, 31, v2
    v_lshrrev_b32 v4, 5, v2
    v_lshlrev_b32 v1, 4, v2
    s_cmp_ge_u32 s18, 32
    s_cbranch_scc1 K1_WMISC
    s_cmp_ge_u32 s18, 16
    s_cbranch_scc1 K1_WU
    s_cmp_ge_u32 s18, 8
    s_cbranch_scc1 K1_W2
    s_lshr_b32 s4, s18, 1
    s_and_b32 s5, s18, 1
    s_lshl_b32 s4, s4, 11
    s_lshl_b32 s5, s5, 6
    s_add_u32 s4, s4, s5
    v_lshlrev_b32 v5, 10, v4
    v_lshl_add_u32 v6, v3, 1, v5
    buffer_load_ushort v8, v6, s[20:23], s4 offen offset:0
    buffer_load_ushort v9, v6, s[20:23], s4 offen offset:128
    buffer_load_ushort v10, v6, s[20:23], s4 offen offset:256
    buffer_load_ushort v11, v6, s[20:23], s4 offen offset:384
    buffer_load_ushort v12, v6, s[20:23], s4 offen offset:512
    buffer_load_ushort v13, v6, s[20:23], s4 offen offset:640
    buffer_load_ushort v14, v6, s[20:23], s4 offen offset:768
    buffer_load_ushort v15, v6, s[20:23], s4 offen offset:896
    v_mov_b32 v40, 0xbfb8aa3b
    s_waitcnt vmcnt(0)
    v_lshlrev_b32 v8, 16, v8
    v_lshlrev_b32 v9, 16, v9
    v_lshlrev_b32 v10, 16, v10
    v_lshlrev_b32 v11, 16, v11
    v_lshlrev_b32 v12, 16, v12
    v_lshlrev_b32 v13, 16, v13
    v_lshlrev_b32 v14, 16, v14
    v_lshlrev_b32 v15, 16, v15
    v_mul_f32 v8, v40, v8
    v_mul_f32 v9, v40, v9
    v_mul_f32 v10, v40, v10
    v_mul_f32 v11, v40, v11
    v_mul_f32 v12, v40, v12
    v_mul_f32 v13, v40, v13
    v_mul_f32 v14, v40, v14
    v_mul_f32 v15, v40, v15
    v_cvt_pk_bf16_f32 v44, v8, v9
    v_cvt_pk_bf16_f32 v45, v10, v11
    v_cvt_pk_bf16_f32 v46, v12, v13
    v_cvt_pk_bf16_f32 v47, v14, v15
    s_lshl_b32 s4, s18, 10
    s_add_u32 s4, s4, 0
    buffer_store_dwordx4 v[44:47], v1, s[36:39], s4 offen
    s_endpgm
K1_W2:
    v_bfe_u32 v5, v3, 2, 1
    v_lshlrev_b32 v5, 4, v5
    v_and_b32 v6, 3, v3
    v_add_u32 v5, v5, v6
    v_lshrrev_b32 v6, 3, v3
    v_lshl_add_u32 v5, v6, 2, v5
    v_lshlrev_b32 v6, 10, v4
    v_lshl_add_u32 v6, v5, 1, v6
    s_sub_u32 s19, s18, 8
    s_and_b32 s4, s19, 3
    s_lshr_b32 s5, s19, 2
    s_lshl_b32 s4, s4, 11
    s_lshl_b32 s5, s5, 6
    s_add_u32 s4, s4, s5
    s_add_u32 s4, s4, 8192
    buffer_load_ushort v8, v6, s[20:23], s4 offen offset:0
    buffer_load_ushort v9, v6, s[20:23], s4 offen offset:128
    buffer_load_ushort v10, v6, s[20:23], s4 offen offset:256
    buffer_load_ushort v11, v6, s[20:23], s4 offen offset:384
    buffer_load_ushort v12, v6, s[20:23], s4 offen offset:512
    buffer_load_ushort v13, v6, s[20:23], s4 offen offset:640
    buffer_load_ushort v14, v6, s[20:23], s4 offen offset:768
    buffer_load_ushort v15, v6, s[20:23], s4 offen offset:896
    s_waitcnt vmcnt(0)
    v_lshl_or_b32 v44, v9, 16, v8
    v_lshl_or_b32 v45, v11, 16, v10
    v_lshl_or_b32 v46, v13, 16, v12
    v_lshl_or_b32 v47, v15, 16, v14
    s_lshl_b32 s4, s19, 10
    s_add_u32 s4, s4, 8192
    buffer_store_dwordx4 v[44:47], v1, s[36:39], s4 offen
    s_endpgm
K1_WU:
    v_bfe_u32 v5, v2, 2, 2
    v_lshlrev_b32 v5, 4, v5
    v_and_b32 v6, 3, v2
    v_add_u32 v5, v5, v6
    v_lshrrev_b32 v6, 4, v2
    v_lshlrev_b32 v6, 10, v6
    v_lshl_add_u32 v6, v5, 1, v6
    s_sub_u32 s19, s18, 16
    s_and_b32 s4, s19, 3
    s_lshr_b32 s5, s19, 2
    s_lshl_b32 s4, s4, 12
    s_lshl_b32 s5, s5, 3
    s_add_u32 s4, s4, s5
    buffer_load_ushort v8, v6, s[24:27], s4 offen offset:0
    buffer_load_ushort v9, v6, s[24:27], s4 offen offset:128
    buffer_load_ushort v10, v6, s[24:27], s4 offen offset:256
    buffer_load_ushort v11, v6, s[24:27], s4 offen offset:384
    buffer_load_ushort v12, v6, s[24:27], s4 offen offset:512
    buffer_load_ushort v13, v6, s[24:27], s4 offen offset:640
    buffer_load_ushort v14, v6, s[24:27], s4 offen offset:768
    buffer_load_ushort v15, v6, s[24:27], s4 offen offset:896
    s_waitcnt vmcnt(0)
    v_lshl_or_b32 v44, v9, 16, v8
    v_lshl_or_b32 v45, v11, 16, v10
    v_lshl_or_b32 v46, v13, 16, v12
    v_lshl_or_b32 v47, v15, 16, v14
    s_lshl_b32 s4, s19, 10
    s_add_u32 s4, s4, 16384
    buffer_store_dwordx4 v[44:47], v1, s[36:39], s4 offen
    s_endpgm
K1_WMISC:
    s_cmp_eq_u32 s18, 32
    s_cbranch_scc0 K1_WLC
    v_lshlrev_b32 v5, 1, v2
    s_mov_b32 s4, 16384
    buffer_load_ushort v8, v5, s[20:23], s4 offen
    v_mov_b32 v40, 0xbfb8aa3b
    s_waitcnt vmcnt(0)
    v_lshlrev_b32 v8, 16, v8
    v_mul_f32 v8, v40, v8
    v_cvt_f16_f32 v9, v8
    v_cvt_pk_bf16_f32 v10, v8, v8
    s_mov_b32 s4, 32768
    buffer_store_short v9, v5, s[36:39], s4 offen
    buffer_store_short v10, v5, s[36:39], s4 offen offset:128
    v_and_b32 v8, 0x7fffffff, v8
    s_nop 1
    v_max_u32_dpp v8, v8, v8 row_shr:1 row_mask:0xf bank_mask:0xf
    s_nop 1
    v_max_u32_dpp v8, v8, v8 row_shr:2 row_mask:0xf bank_mask:0xf
    s_nop 1
    v_max_u32_dpp v8, v8, v8 row_shr:4 row_mask:0xf bank_mask:0xf
    s_nop 1
    v_max_u32_dpp v8, v8, v8 row_shr:8 row_mask:0xf bank_mask:0xf
    s_nop 1
    v_max_u32_dpp v8, v8, v8 row_bcast:15 row_mask:0xa bank_mask:0xf
    s_nop 1
    v_max_u32_dpp v8, v8, v8 row_bcast:31 row_mask:0xc bank_mask:0xf
    v_mov_b32 v5, 33024
    s_mov_b32 exec_lo, 0
    s_mov_b32 exec_hi, 0x80000000
    buffer_store_dword v8, v5, s[36:39], 0 offen
    s_endpgm
K1_WLC:
    s_cmp_eq_u32 s18, 33
    s_cbranch_scc0 K1_END
    v_and_b32 v3, 31, v2
    v_lshrrev_b32 v4, 5, v2
    v_lshlrev_b32 v5, 3, v4
    v_sub_u32 v5, v3, v5
    v_cmp_eq_u32 s[4:5], 0, v5
    v_cmp_eq_u32 s[6:7], 1, v5
    v_mov_b32 v6, 0x3c00
    v_mov_b32 v7, 0x3c000000
    v_cndmask_b32 v8, 0, v6, s[4:5]
    v_cndmask_b32 v7, 0, v7, s[6:7]
    v_or_b32 v8, v8, v7
    v_cmp_eq_u32 s[4:5], 2, v5
    v_cmp_eq_u32 s[6:7], 3, v5
    v_mov_b32 v6, 0x3c00
    v_mov_b32 v7, 0x3c000000
    v_cndmask_b32 v9, 0, v6, s[4:5]
    v_cndmask_b32 v7, 0, v7, s[6:7]
    v_or_b32 v9, v9, v7
    v_cmp_eq_u32 s[4:5], 4, v5
    v_cmp_eq_u32 s[6:7], 5, v5
    v_mov_b32 v6, 0x3c00
    v_mov_b32 v7, 0x3c000000
    v_cndmask_b32 v10, 0, v6, s[4:5]
    v_cndmask_b32 v7, 0, v7, s[6:7]
    v_or_b32 v10, v10, v7
    v_cmp_eq_u32 s[4:5], 6, v5
    v_cmp_eq_u32 s[6:7], 7, v5
    v_mov_b32 v6, 0x3c00
    v_mov_b32 v7, 0x3c000000
    v_cndmask_b32 v11, 0, v6, s[4:5]
    v_cndmask_b32 v7, 0, v7, s[6:7]
    v_or_b32 v11, v11, v7
    v_cmp_eq_u32 s[4:5], 16, v5
    v_cmp_eq_u32 s[6:7], 17, v5
    v_mov_b32 v6, 0x3c00
    v_mov_b32 v7, 0x3c000000
    v_cndmask_b32 v12, 0, v6, s[4:5]
    v_cndmask_b32 v7, 0, v7, s[6:7]
    v_or_b32 v12, v12, v7
    v_cmp_eq_u32 s[4:5], 18, v5
    v_cmp_eq_u32 s[6:7], 19, v5
    v_mov_b32 v6, 0x3c00
    v_mov_b32 v7, 0x3c000000
    v_cndmask_b32 v13, 0, v6, s[4:5]
    v_cndmask_b32 v7, 0, v7, s[6:7]
    v_or_b32 v13, v13, v7
    v_cmp_eq_u32 s[4:5], 20, v5
    v_cmp_eq_u32 s[6:7], 21, v5
    v_mov_b32 v6, 0x3c00
    v_mov_b32 v7, 0x3c000000
    v_cndmask_b32 v14, 0, v6, s[4:5]
    v_cndmask_b32 v7, 0, v7, s[6:7]
    v_or_b32 v14, v14, v7
    v_cmp_eq_u32 s[4:5], 22, v5
    v_cmp_eq_u32 s[6:7], 23, v5
    v_mov_b32 v6, 0x3c00
    v_mov_b32 v7, 0x3c000000
    v_cndmask_b32 v15, 0, v6, s[4:5]
    v_cndmask_b32 v7, 0, v7, s[6:7]
    v_or_b32 v15, v15, v7
    v_lshrrev_b32 v5, 2, v3
    v_lshlrev_b32 v6, 2, v4
    v_sub_u32 v5, v5, v6
    v_mov_b32 v6, 0x3c00
    v_cmp_eq_u32 s[4:5], 0, v5
    s_nop 1
    v_cndmask_b32 v16, 0, v6, s[4:5]
    v_cmp_eq_u32 s[4:5], 1, v5
    s_nop 1
    v_cndmask_b32 v17, 0, v6, s[4:5]
    v_cmp_eq_u32 s[4:5], 2, v5
    s_nop 1
    v_cndmask_b32 v18, 0, v6, s[4:5]
    v_cmp_eq_u32 s[4:5], 3, v5
    s_nop 1
    v_cndmask_b32 v19, 0, v6, s[4:5]
    v_cmp_eq_u32 s[4:5], 0, v4
    v_mov_b32 v6, 0xfffe0000
    s_nop 0
    v_cndmask_b32 v20, 0, v6, s[4:5]
    v_bfe_u32 v5, v2, 2, 2
    v_and_b32 v6, 1, v5
    v_xor_b32 v21, 1, v6
    v_lshlrev_b32 v21, 5, v21
    v_bfe_u32 v7, v2, 4, 1
    v_lshlrev_b32 v7, 5, v7
    v_and_b32 v32, 3, v2
    v_lshl_add_u32 v7, v32, 3, v7
    v_add_u32 v7, 138624, v7
    s_mov_b32 s4, 25088
    v_mad_u32_u24 v22, v6, s4, v7
    v_lshlrev_b32 v23, 2, v3
    v_add_u32 v25, 4656, v23
    v_add_u32 v23, 85040, v23
    v_lshrrev_b32 v6, 3, v2
    v_lshlrev_b32 v6, 2, v6
    v_add_u32 v24, 4656, v6
    v_lshrrev_b32 v6, 1, v5
    v_lshl_add_u32 v6, v4, 2, v6
    v_lshlrev_b32 v26, 2, v6
    v_lshlrev_b32 v27, 2, v4
    v_and_b32 v6, 7, v2
    v_bfe_u32 v7, v2, 4, 1
    v_lshlrev_b32 v7, 2, v7
    v_xor_b32 v6, v6, v7
    v_lshlrev_b32 v28, 4, v6
    v_lshl_add_u32 v6, v4, 3, v5
    v_lshlrev_b32 v6, 7, v6
    v_bfe_u32 v7, v2, 4, 1
    v_lshl_add_u32 v6, v7, 5, v6
    v_and_b32 v7, 3, v2
    v_lshl_add_u32 v6, v7, 3, v6
    v_lshrrev_b32 v7, 1, v5
    v_lshl_add_u32 v29, v7, 6, v6
    v_xor_b32 v30, 64, v29
    v_mov_b32 v31, 68
    v_lshlrev_b32 v1, 4, v2
    s_mov_b32 s4, 33792
    buffer_store_dwordx4 v[8:11], v1, s[36:39], s4 offen
    s_mov_b32 s4, 34816
    buffer_store_dwordx4 v[12:15], v1, s[36:39], s4 offen
    s_mov_b32 s4, 35840
    buffer_store_dwordx4 v[16:19], v1, s[36:39], s4 offen
    s_mov_b32 s4, 36864
    buffer_store_dwordx4 v[20:23], v1, s[36:39], s4 offen
    s_mov_b32 s4, 37888
    buffer_store_dwordx4 v[24:27], v1, s[36:39], s4 offen
    s_mov_b32 s4, 38912
    buffer_store_dwordx4 v[28:31], v1, s[36:39], s4 offen
K1_END:
    s_endpgm
.globl k2_kernel
.p2align 8
.type k2_kernel,@function
k2_kernel:
    s_cmp_ge_u32 s2, 256
    s_cbranch_scc1 K2_END
    s_and_b32 s3, s2, 7
    s_lshl_b32 s3, s3, 5
    s_lshr_b32 s2, s2, 3
    s_add_u32 s2, s2, s3
    s_load_dwordx2 s[4:5], s[0:1], 0
    s_load_dwordx2 s[6:7], s[0:1], 48
    s_load_dwordx2 s[8:9], s[0:1], 64
    v_mov_b32 v32, v0
    v_and_b32 v33, 63, v0
    v_lshrrev_b32 v1, 6, v0
    v_lshrrev_b32 v120, 3, v32
    v_lshlrev_b32 v120, 10, v120
    s_lshl_b32 s3, s2, 2
    v_add_u32 v120, s3, v120
    v_readfirstlane_b32 s40, v1
    s_waitcnt lgkmcnt(0)
    s_add_u32 s28, s8, 4194304
    s_addc_u32 s29, s9, 0
    s_and_b32 s29, s29, 0xffff
    s_mov_b32 s30, 128000
    s_mov_b32 s31, 0x20000
    buffer_load_dword v34, v120, s[28:31], 0 offen
    s_mov_b32 s20, s8
    s_and_b32 s21, s9, 0xffff
    s_mov_b32 s22, 4587520
    s_mov_b32 s23, 0x20000
    s_add_u32 s36, s8, 4521984
    s_addc_u32 s37, s9, 0
    s_and_b32 s37, s37, 0xffff
    s_mov_b32 s38, 45056
    s_mov_b32 s39, 0x20000
    s_mov_b32 s60, 0
    s_mov_b32 s69, 64
    s_cmp_lt_u32 s40, 2
    s_cbranch_scc0 SM_2
    s_cmp_eq_u32 s40, 0
    s_cbranch_scc1 SM_1
    v_lshlrev_b32 v124, 3, v33
    s_add_u32 s32, s8, 4456448
    s_addc_u32 s33, s9, 0
    s_and_b32 s33, s33, 0xffff
    s_mov_b32 s34, 500
    s_mov_b32 s35, 0x20000
    buffer_load_dwordx2 v[72:73], v124, s[32:35], 0 offen
    s_add_u32 s32, s8, 4456960
    s_addc_u32 s33, s9, 0
    s_and_b32 s33, s33, 0xffff
    s_mov_b32 s34, 484
    s_mov_b32 s35, 0x20000
    buffer_load_dwordx2 v[74:75], v124, s[32:35], 0 offen
    s_add_u32 s32, s8, 4457472
    s_addc_u32 s33, s9, 0
    s_and_b32 s33, s33, 0xffff
    s_mov_b32 s34, 484
    s_mov_b32 s35, 0x20000
    buffer_load_dwordx2 v[76:77], v124, s[32:35], 0 offen
    s_mov_b32 s63, 33024
    v_mov_b32 v124, 0
    buffer_load_dword v78, v124, s[36:39], s63 offen
    s_branch SM_2
SM_1:
    v_lshlrev_b32 v124, 1, v33
    s_mov_b32 s63, 32768
    buffer_load_ushort v27, v124, s[36:39], s63 offen
SM_2:
    s_waitcnt vmcnt(0)
    v_lshrrev_b32 v120, 3, v32
    s_movk_i32 s63, 6400
    v_and_b32 v121, 0xffff, v34
    v_mad_u32_u24 v120, v120, s63, v121
    v_add_u32 v120, s60, v120
    v_and_b32 v121, 7, v32
    v_lshl_add_u32 v122, v121, 2, v120
    v_lshl_add_u32 v123, v121, 1, v120
    s_mov_b32 s63, 3276800
    buffer_load_dword v44, v122, s[20:23], s63 offen
    v_lshlrev_b32 v122, 2, v122
    buffer_load_dwordx4 v[36:39], v122, s[20:23], 0 offen
    v_lshrrev_b32 v120, 16, v34
    v_subrev_u32 v120, s60, v120
    v_min_i32 v120, s69, v120
    v_lshlrev_b32 v122, 2, v121
    v_sub_u32 v122, v120, v122
    v_cmp_lt_i32 s[44:45], 0, v122
    v_cmp_lt_i32 s[46:47], 1, v122
    v_cmp_lt_i32 s[48:49], 2, v122
    v_cmp_lt_i32 s[50:51], 3, v122
    v_lshlrev_b32 v121, 1, v121
    v_sub_u32 v121, v120, v121
    v_cmp_lt_i32 s[52:53], 32, v121
    v_cmp_lt_i32 s[54:55], 33, v121
    v_cmp_lt_i32 s[56:57], 48, v121
    v_cmp_lt_i32 s[58:59], 49, v121
    v_lshrrev_b32 v125, 16, v34
    v_cmp_lt_u32 vcc, 32, v125
    s_mov_b64 s[70:71], vcc
    s_mov_b64 s[64:65], 0
    s_cmp_eq_u64 vcc, 0
    s_cbranch_scc1 NC_3
    s_mov_b32 s63, 3276800
    buffer_load_ushort v46, v123, s[20:23], s63 offen offset:32
    v_lshlrev_b32 v122, 2, v123
    buffer_load_dwordx2 v[40:41], v122, s[20:23], 0 offen offset:128
    v_cmp_lt_u32 vcc, 48, v125
    s_mov_b64 s[64:65], vcc
    s_cmp_eq_u64 vcc, 0
    s_cbranch_scc1 NC_3
    s_mov_b32 s63, 3276800
    buffer_load_ushort v45, v123, s[20:23], s63 offen offset:48
    v_lshlrev_b32 v122, 2, v123
    buffer_load_dwordx2 v[42:43], v122, s[20:23], 0 offen offset:192
NC_3:
    s_lshl_b32 s43, s40, 12
    s_add_u32 s43, s43, 19504
    v_lshlrev_b32 v122, 4, v33
    s_sub_u32 s72, s40, 9
    s_cmp_lt_u32 s72, 2
    s_cbranch_scc0 ST_4
    s_lshl_b32 s72, s72, 12
    s_add_u32 s72, s72, 33792
    s_mov_b32 m0, s43
    s_nop 0
    buffer_load_dwordx4 v122, s[36:39], s72 offen lds
    s_add_u32 m0, m0, 1024
    s_add_u32 s72, s72, 1024
    buffer_load_dwordx4 v122, s[36:39], s72 offen lds
    s_add_u32 m0, m0, 1024
    s_add_u32 s72, s72, 1024
    buffer_load_dwordx4 v122, s[36:39], s72 offen lds
    s_add_u32 m0, m0, 1024
    s_add_u32 s72, s72, 1024
    buffer_load_dwordx4 v122, s[36:39], s72 offen lds
ST_4:
    s_sub_u32 s72, s40, 2
    s_cmp_lt_u32 s72, 7
    s_cbranch_scc0 ST_5
    s_add_u32 s32, s8, 11665408
    s_addc_u32 s33, s9, 0
    s_and_b32 s33, s33, 0xffff
    s_mov_b32 s34, 6400000
    s_mov_b32 s35, 0x20000
    s_lshl_b32 s72, s72, 12
    s_add_u32 s73, s72, 138624
    s_mov_b32 m0, s73
    s_mul_i32 s73, s2, 25088
    s_add_u32 s72, s72, s73
    s_cmp_eq_u32 s40, 8
    s_cbranch_scc1 ST_6
    buffer_load_dwordx4 v122, s[32:35], s72 offen lds
    s_add_u32 m0, m0, 1024
    s_add_u32 s72, s72, 1024
    buffer_load_dwordx4 v122, s[32:35], s72 offen lds
    s_add_u32 m0, m0, 1024
    s_add_u32 s72, s72, 1024
    buffer_load_dwordx4 v122, s[32:35], s72 offen lds
    s_add_u32 m0, m0, 1024
    s_add_u32 s72, s72, 1024
    buffer_load_dwordx4 v122, s[32:35], s72 offen lds
    s_branch ST_5
ST_6:
    s_mov_b32 exec_hi, 0
    buffer_load_dwordx4 v122, s[32:35], s72 offen lds
    buffer_load_dwordx4 v122, s[32:35], s72 offen lds
    buffer_load_dwordx4 v122, s[32:35], s72 offen lds
    buffer_load_dwordx4 v122, s[32:35], s72 offen lds
    s_mov_b64 exec, -1
ST_5:
    v_lshlrev_b32 v116, 4, v32
    v_mov_b32 v112, 0
    v_mov_b32 v113, 0
    v_mov_b32 v114, 0
    v_mov_b32 v115, 0
    v_cmp_gt_u32 vcc, 192, v32
    s_and_b64 exec, exec, vcc
    ds_write_b128 v116, v[112:115] offset:19504
    v_cmp_gt_u32 vcc, 59, v32
    s_and_b64 exec, exec, vcc
    ds_write_b128 v116, v[112:115] offset:3712
    s_mov_b64 exec, -1
    v_add_u32 v117, 85040, v116
    ds_write_b128 v117, v[112:115] offset:0
    ds_write_b128 v117, v[112:115] offset:16384
    ds_write_b128 v117, v[112:115] offset:32768
    v_cmp_gt_u32 vcc, 277, v32
    s_and_b64 exec, exec, vcc
    ds_write_b128 v117, v[112:115] offset:49152
    s_mov_b64 exec, -1
    v_mov_b32 v112, 0xffff
    v_mov_b32 v113, 0xffff
    v_mov_b32 v114, 0xffff
    v_mov_b32 v115, 0xffff
    v_cmp_gt_u32 vcc, 928, v32
    s_and_b64 exec, exec, vcc
    ds_write_b128 v116, v[112:115] offset:4656
    v_cmp_gt_u32 vcc, 232, v32
    s_and_b64 exec, exec, vcc
    v_mov_b32 v112, 784
    v_mov_b32 v113, 784
    v_mov_b32 v114, 784
    v_mov_b32 v115, 784
    ds_write_b128 v116, v[112:115] offset:0
    s_mov_b64 exec, -1
    s_add_u32 s12, s8, 5242880
    s_addc_u32 s13, s9, 0
    s_and_b32 s13, s13, 0xffff
    s_or_b32 s13, s13, 8388608
    s_mov_b32 s14, 50000
    s_mov_b32 s15, 0x20000
    s_mov_b32 s16, s4
    s_and_b32 s17, s5, 0xffff
    s_mov_b32 s18, 6400000
    s_mov_b32 s19, 0x20000
    s_mov_b32 s24, s6
    s_and_b32 s25, s7, 0xffff
    s_mov_b32 s26, 6400000
    s_mov_b32 s27, 0x20000
    v_mov_b32 v30, 1
    v_mov_b32 v31, 2
    s_waitcnt lgkmcnt(0)
    s_barrier
    v_lshlrev_b32 v124, 2, v33
    v_lshrrev_b32 v125, 16, v34
    ds_max_u32 v124, v125 offset:22320
    s_sub_u32 s72, s40, 2
    s_cmp_lt_u32 s72, 9
    s_cbranch_scc0 RW_7
    s_waitcnt vmcnt(4)
    s_branch RW_8
RW_7:
    s_waitcnt vmcnt(0)
RW_8:
    v_lshlrev_b32_sdwa v48, v31, v44 dst_sel:DWORD dst_unused:UNUSED_PAD src0_sel:DWORD src1_sel:BYTE_0
    v_lshlrev_b32_sdwa v49, v31, v44 dst_sel:DWORD dst_unused:UNUSED_PAD src0_sel:DWORD src1_sel:BYTE_1
    v_lshlrev_b32_sdwa v50, v31, v44 dst_sel:DWORD dst_unused:UNUSED_PAD src0_sel:DWORD src1_sel:BYTE_2
    v_lshlrev_b32_sdwa v51, v31, v44 dst_sel:DWORD dst_unused:UNUSED_PAD src0_sel:DWORD src1_sel:BYTE_3
    s_mov_b64 exec, s[44:45]
    ds_add_rtn_u32 v56, v48, v30 offset:19504
    s_mov_b64 exec, s[46:47]
    ds_add_rtn_u32 v57, v49, v30 offset:19504
    s_mov_b64 exec, s[48:49]
    ds_add_rtn_u32 v58, v50, v30 offset:19504
    s_mov_b64 exec, s[50:51]
    ds_add_rtn_u32 v59, v51, v30 offset:19504
    s_mov_b64 exec, -1
    s_cmp_eq_u64 s[70:71], 0
    s_cbranch_scc1 NC_9
    v_lshlrev_b32_sdwa v52, v31, v46 dst_sel:DWORD dst_unused:UNUSED_PAD src0_sel:DWORD src1_sel:BYTE_0
    v_lshlrev_b32_sdwa v53, v31, v46 dst_sel:DWORD dst_unused:UNUSED_PAD src0_sel:DWORD src1_sel:BYTE_1
    s_mov_b64 exec, s[52:53]
    ds_add_rtn_u32 v60, v52, v30 offset:19504
    s_mov_b64 exec, s[54:55]
    ds_add_rtn_u32 v61, v53, v30 offset:19504
    s_mov_b64 exec, -1
    s_cmp_eq_u64 s[64:65], 0
    s_cbranch_scc1 NC_9
    v_lshlrev_b32_sdwa v54, v31, v45 dst_sel:DWORD dst_unused:UNUSED_PAD src0_sel:DWORD src1_sel:BYTE_0
    v_lshlrev_b32_sdwa v55, v31, v45 dst_sel:DWORD dst_unused:UNUSED_PAD src0_sel:DWORD src1_sel:BYTE_1
    s_mov_b64 exec, s[56:57]
    ds_add_rtn_u32 v62, v54, v30 offset:19504
    s_mov_b64 exec, s[58:59]
    ds_add_rtn_u32 v63, v55, v30 offset:19504
    s_mov_b64 exec, -1
NC_9:
    v_and_b32 v104, 0xffff0000, v36
    v_and_b32 v105, 0xffff0000, v37
    v_and_b32 v106, 0xffff0000, v38
    v_and_b32 v107, 0xffff0000, v39
    v_cvt_f16_f32_sdwa v36, v104 dst_sel:WORD_1 dst_unused:UNUSED_PRESERVE src0_sel:DWORD
    v_cvt_f16_f32_sdwa v37, v105 dst_sel:WORD_1 dst_unused:UNUSED_PRESERVE src0_sel:DWORD
    v_cvt_f16_f32_sdwa v38, v106 dst_sel:WORD_1 dst_unused:UNUSED_PRESERVE src0_sel:DWORD
    v_cvt_f16_f32_sdwa v39, v107 dst_sel:WORD_1 dst_unused:UNUSED_PRESERVE src0_sel:DWORD
    v_or_b32 v36, 0x10000, v36
    v_or_b32 v37, 0x10000, v37
    v_or_b32 v38, 0x10000, v38
    v_or_b32 v39, 0x10000, v39
    s_cmp_eq_u64 s[70:71], 0
    s_cbranch_scc1 NC_10
    v_and_b32 v104, 0xffff0000, v40
    v_and_b32 v105, 0xffff0000, v41
    v_cvt_f16_f32_sdwa v40, v104 dst_sel:WORD_1 dst_unused:UNUSED_PRESERVE src0_sel:DWORD
    v_cvt_f16_f32_sdwa v41, v105 dst_sel:WORD_1 dst_unused:UNUSED_PRESERVE src0_sel:DWORD
    v_or_b32 v40, 0x10000, v40
    v_or_b32 v41, 0x10000, v41
    s_cmp_eq_u64 s[64:65], 0
    s_cbranch_scc1 NC_10
    v_and_b32 v104, 0xffff0000, v42
    v_and_b32 v105, 0xffff0000, v43
    v_cvt_f16_f32_sdwa v42, v104 dst_sel:WORD_1 dst_unused:UNUSED_PRESERVE src0_sel:DWORD
    v_cvt_f16_f32_sdwa v43, v105 dst_sel:WORD_1 dst_unused:UNUSED_PRESERVE src0_sel:DWORD
    v_or_b32 v42, 0x10000, v42
    v_or_b32 v43, 0x10000, v43
NC_10:
    s_sub_u32 s72, s40, 9
    s_cmp_lt_u32 s72, 2
    s_cbranch_scc0 RW_11
    s_waitcnt vmcnt(0)
RW_11:
    s_waitcnt lgkmcnt(0)
    s_barrier
    v_add_u32 v126, 56368, v122
    ds_read_b128 v[0:3], v126 offset:0
    ds_read_b128 v[4:7], v126 offset:1024
    ds_read_b128 v[8:11], v126 offset:2048
    ds_read_b128 v[12:15], v126 offset:3072
    ds_read_b128 v[16:19], v126 offset:4096
    ds_read_b128 v[20:23], v126 offset:5120
    s_cmp_eq_u32 s40, 0
    s_cbranch_scc0 SC_12
    v_lshlrev_b32 v112, 4, v33
    ds_read_b128 v[104:107], v112 offset:19504
    s_waitcnt lgkmcnt(0)
    v_max_u32 v113, v104, v105
    v_max3_u32 v113, v113, v106, v107
    v_add_u32 v104, 3, v104
    v_add_u32 v105, 3, v105
    v_add_u32 v106, 3, v106
    v_add_u32 v107, 3, v107
    v_and_b32 v104, -4, v104
    v_and_b32 v105, -4, v105
    v_and_b32 v106, -4, v106
    v_and_b32 v107, -4, v107
    v_add_u32 v114, v104, v105
    v_add_u32 v115, v106, v107
    v_add_u32 v114, v114, v115
    v_mov_b32 v115, v114
    s_nop 1
    v_add_u32_dpp v115, v115, v115 row_shr:1 row_mask:0xf bank_mask:0xf
    s_nop 1
    v_add_u32_dpp v115, v115, v115 row_shr:2 row_mask:0xf bank_mask:0xf
    s_nop 1
    v_add_u32_dpp v115, v115, v115 row_shr:4 row_mask:0xf bank_mask:0xf
    s_nop 1
    v_add_u32_dpp v115, v115, v115 row_shr:8 row_mask:0xf bank_mask:0xf
    s_nop 1
    v_add_u32_dpp v115, v115, v115 row_bcast:15 row_mask:0xa bank_mask:0xf
    s_nop 1
    v_add_u32_dpp v115, v115, v115 row_bcast:31 row_mask:0xc bank_mask:0xf
    v_sub_u32 v108, v115, v114
    v_add_u32 v109, v108, v104
    v_add_u32 v110, v109, v105
    v_add_u32 v111, v110, v106
    ds_write_b128 v112, v[108:111] offset:20528
    v_readlane_b32 s72, v115, 63
    s_movk_i32 s63, 1020
    v_cmp_lt_u32 vcc, s63, v113
    s_cmp_eq_u64 vcc, 0
    s_cselect_b32 s68, 1, 0
    s_cmp_le_u32 s72, 3712
    s_cselect_b32 s68, s68, 0
    s_add_u32 s42, s72, 31
    s_lshr_b32 s42, s42, 5
    v_lshrrev_b32 v104, 2, v104
    v_lshrrev_b32 v105, 2, v105
    v_lshrrev_b32 v106, 2, v106
    v_lshrrev_b32 v107, 2, v107
    v_mov_b32 v108, s42
    v_mov_b32 v109, s68
    v_mov_b32 v110, 0
    v_mov_b32 v111, 32
    s_mov_b32 exec_hi, 0x1ffff
    ds_write_b128 v112, v[104:107] offset:3712
    s_mov_b64 exec, 1
    ds_write_b64 v110, v[108:109] offset:4512
    ds_write_b32 v110, v111 offset:4528
    s_mov_b64 exec, -1
SC_12:
    s_cmp_eq_u32 s40, 1
    s_cbranch_scc0 K2_NODEC
    v_lshlrev_b32 v84, 2, v33
    ds_read_b32 v83, v84 offset:22320
    v_max_u32 v81, v72, v73
    v_max_u32 v80, v74, v75
    v_max_u32 v82, v76, v77
    v_mov_b32 v85, v78
    v_mov_b32 v86, 0
    s_waitcnt lgkmcnt(0)
    v_max_u32_dpp v80, v80, v80 row_shr:1 row_mask:0xf bank_mask:0xf
    v_max_u32_dpp v81, v81, v81 row_shr:1 row_mask:0xf bank_mask:0xf
    v_max_u32_dpp v82, v82, v82 row_shr:1 row_mask:0xf bank_mask:0xf
    v_max_u32_dpp v83, v83, v83 row_shr:1 row_mask:0xf bank_mask:0xf
    v_max_u32_dpp v80, v80, v80 row_shr:2 row_mask:0xf bank_mask:0xf
    v_max_u32_dpp v81, v81, v81 row_shr:2 row_mask:0xf bank_mask:0xf
    v_max_u32_dpp v82, v82, v82 row_shr:2 row_mask:0xf bank_mask:0xf
    v_max_u32_dpp v83, v83, v83 row_shr:2 row_mask:0xf bank_mask:0xf
    v_max_u32_dpp v80, v80, v80 row_shr:4 row_mask:0xf bank_mask:0xf
    v_max_u32_dpp v81, v81, v81 row_shr:4 row_mask:0xf bank_mask:0xf
    v_max_u32_dpp v82, v82, v82 row_shr:4 row_mask:0xf bank_mask:0xf
    v_max_u32_dpp v83, v83, v83 row_shr:4 row_mask:0xf bank_mask:0xf
    v_max_u32_dpp v80, v80, v80 row_shr:8 row_mask:0xf bank_mask:0xf
    v_max_u32_dpp v81, v81, v81 row_shr:8 row_mask:0xf bank_mask:0xf
    v_max_u32_dpp v82, v82, v82 row_shr:8 row_mask:0xf bank_mask:0xf
    v_max_u32_dpp v83, v83, v83 row_shr:8 row_mask:0xf bank_mask:0xf
    v_max_u32_dpp v80, v80, v80 row_bcast:15 row_mask:0xa bank_mask:0xf
    v_max_u32_dpp v81, v81, v81 row_bcast:15 row_mask:0xa bank_mask:0xf
    v_max_u32_dpp v82, v82, v82 row_bcast:15 row_mask:0xa bank_mask:0xf
    v_max_u32_dpp v83, v83, v83 row_bcast:15 row_mask:0xa bank_mask:0xf
    v_max_u32_dpp v80, v80, v80 row_bcast:31 row_mask:0xc bank_mask:0xf
    v_max_u32_dpp v81, v81, v81 row_bcast:31 row_mask:0xc bank_mask:0xf
    v_max_u32_dpp v82, v82, v82 row_bcast:31 row_mask:0xc bank_mask:0xf
    v_max_u32_dpp v83, v83, v83 row_bcast:31 row_mask:0xc bank_mask:0xf
    s_nop 0
    v_readlane_b32 s72, v80, 63
    v_readlane_b32 s73, v81, 63
    v_readlane_b32 s63, v82, 63
    v_readlane_b32 s62, v83, 63
    v_mov_b32 v80, s73
    v_mov_b32 v81, v85
    v_mov_b32 v82, s72
    v_mov_b32 v83, s63
    v_fma_f32 v82, v80, v81, v82
    v_add_f32 v82, v82, v83
    v_mul_f32 v82, 0x3f804189, v82
    v_mov_b32 v83, 0x44800000
    v_cmp_ge_f32 vcc, 0x41f80000, v82
    s_mov_b64 s[74:75], vcc
    v_cmp_le_f32 vcc, v80, v83
    s_and_b64 s[74:75], s[74:75], vcc
    v_cmp_le_f32 vcc, v81, v83
    s_and_b64 s[74:75], s[74:75], vcc
    s_cmp_eq_u64 s[74:75], -1
    s_cselect_b32 s61, 1, 0
    s_cmp_le_u32 s62, 64
    s_cselect_b32 s61, s61, 0
    v_mul_f32 v82, 4.0, v82
    v_min_f32 v83, 2.0, v82
    v_add_f32 v84, v82, v83
    v_mul_f32 v84, 0x3f8147ae, v84
    v_max_f32 v84, 0xda24260, v84
    v_lshrrev_b32 v84, 23, v84
    v_add_u32 v84, 1, v84
    v_lshlrev_b32 v85, 23, v84
    v_add_f32 v85, v85, v85
    v_mul_f32 v83, 0x3f80a3d7, v83
    v_sub_f32 v80, v85, v83
    v_subrev_u32 v84, 23, v84
    v_lshlrev_b32 v84, 23, v84
    v_mul_f32 v81, 0xbf317218, v84
    v_mov_b32 v82, s61
    v_mov_b32 v83, s62
    s_mov_b64 exec, 1
    ds_write_b128 v86, v[80:83] offset:4544
    s_mov_b64 exec, -1
K2_NODEC:
    s_waitcnt lgkmcnt(0)
    s_barrier
    v_mov_b32 v120, 0
    ds_read_b64 v[120:121], v120 offset:4512
    ds_read_b32 v64, v48 offset:20528
    ds_read_b32 v65, v49 offset:20528
    ds_read_b32 v66, v50 offset:20528
    ds_read_b32 v67, v51 offset:20528
    s_waitcnt lgkmcnt(0)
    v_readfirstlane_b32 s42, v120
    v_readfirstlane_b32 s68, v121
    s_cmp_eq_u32 s68, 0
    s_cbranch_scc1 NS_13
    v_add_u32 v56, v64, v56
    v_add_u32 v57, v65, v57
    v_add_u32 v58, v66, v58
    v_add_u32 v59, v67, v59
    v_lshlrev_b32 v64, 2, v56
    v_and_b32 v56, -4, v56
    v_lshlrev_b32 v65, 2, v57
    v_and_b32 v57, -4, v57
    v_lshlrev_b32 v66, 2, v58
    v_and_b32 v58, -4, v58
    v_lshlrev_b32 v67, 2, v59
    v_and_b32 v59, -4, v59
    s_mov_b64 exec, s[44:45]
    ds_write_b32 v64, v36 offset:4656
    ds_write_b32 v56, v48 offset:0
    s_mov_b64 exec, s[46:47]
    ds_write_b32 v65, v37 offset:4656
    ds_write_b32 v57, v49 offset:0
    s_mov_b64 exec, s[48:49]
    ds_write_b32 v66, v38 offset:4656
    ds_write_b32 v58, v50 offset:0
    s_mov_b64 exec, s[50:51]
    ds_write_b32 v67, v39 offset:4656
    ds_write_b32 v59, v51 offset:0
    s_mov_b64 exec, -1
    s_cmp_eq_u64 s[70:71], 0
    s_cbranch_scc1 NC_14
    ds_read_b32 v68, v52 offset:20528
    ds_read_b32 v69, v53 offset:20528
    s_waitcnt lgkmcnt(0)
    v_add_u32 v60, v68, v60
    v_add_u32 v61, v69, v61
    v_lshlrev_b32 v68, 2, v60
    v_and_b32 v60, -4, v60
    v_lshlrev_b32 v69, 2, v61
    v_and_b32 v61, -4, v61
    s_mov_b64 exec, s[52:53]
    ds_write_b32 v68, v40 offset:4656
    ds_write_b32 v60, v52 offset:0
    s_mov_b64 exec, s[54:55]
    ds_write_b32 v69, v41 offset:4656
    ds_write_b32 v61, v53 offset:0
    s_mov_b64 exec, -1
    s_cmp_eq_u64 s[64:65], 0
    s_cbranch_scc1 NC_14
    ds_read_b32 v70, v54 offset:20528
    ds_read_b32 v71, v55 offset:20528
    s_waitcnt lgkmcnt(0)
    v_add_u32 v62, v70, v62
    v_add_u32 v63, v71, v63
    v_lshlrev_b32 v70, 2, v62
    v_and_b32 v62, -4, v62
    v_lshlrev_b32 v71, 2, v63
    v_and_b32 v63, -4, v63
    s_mov_b64 exec, s[56:57]
    ds_write_b32 v70, v42 offset:4656
    ds_write_b32 v62, v54 offset:0
    s_mov_b64 exec, s[58:59]
    ds_write_b32 v71, v43 offset:4656
    ds_write_b32 v63, v55 offset:0
    s_mov_b64 exec, -1
NC_14:
NS_13:
    s_cmp_eq_u32 s40, 0
    s_cbranch_scc0 W3_15
    v_lshlrev_b32 v125, 1, v33
    v_add_u32 v125, 163712, v125
    ds_write_b16 v125, v27
W3_15:
    s_waitcnt lgkmcnt(0)
    v_add_u32 v21, s43, v21
    v_add_u32 v22, s43, v22
    v_mov_b32 v25, v20
    v_mov_b32 v27, v20
    v_mov_b32 v29, v20
    v_mov_b32 v31, v20
    v_mov_b32 v120, 0
    s_waitcnt vmcnt(0)
    s_barrier
    ds_read_b128 v[120:123], v120 offset:4544
    v_mov_b32 v109, 4528
    v_mov_b32 v110, 1
    s_waitcnt lgkmcnt(0)
    v_readfirstlane_b32 s66, v120
    v_readfirstlane_b32 s67, v121
    v_readfirstlane_b32 s63, v122
    v_readfirstlane_b32 s62, v123
    s_and_b32 s68, s68, s63
    s_cmp_eq_u32 s68, 0
    s_cbranch_scc1 K2_SLOW
    v_mov_b32 v106, s66
    s_mov_b32 s41, s40
    s_add_u32 s65, s40, 16
    s_cmp_ge_u32 s41, s42
    s_cbranch_scc1 ML_END_F
    s_lshl_b32 s63, s41, 7
    v_add_u32 v96, s63, v16
    ds_read_u16 v24, v96 offset:0
    ds_read_u16 v26, v96 offset:32
    ds_read_u16 v28, v96 offset:64
    ds_read_u16 v30, v96 offset:96
    s_waitcnt lgkmcnt(0)
    s_mov_b32 m0, s43
    s_nop 0
    buffer_load_dwordx4 v[24:25], s[12:15], 0 idxen offen lds
    s_add_u32 m0, m0, 1024
    s_nop 0
    buffer_load_dwordx4 v[26:27], s[12:15], 0 idxen offen lds
    s_add_u32 m0, m0, 1024
    s_nop 0
    buffer_load_dwordx4 v[28:29], s[12:15], 0 idxen offen lds
    s_add_u32 m0, m0, 1024
    s_nop 0
    buffer_load_dwordx4 v[30:31], s[12:15], 0 idxen offen lds
    s_lshl_b32 s72, s41, 7
    s_lshl_b32 s73, s41, 5
    s_lshl_b32 s63, s65, 7
    v_add_u32 v97, s72, v17
    v_add_u32 v98, s73, v18
    v_add_u32 v99, s73, v19
    v_add_u32 v96, s63, v16
    .p2align 3
ML_F:
    s_setprio 2
    ds_read_u16 v24, v96 offset:0
    ds_read_u16 v26, v96 offset:32
    ds_read_u16 v28, v96 offset:64
    ds_read_u16 v30, v96 offset:96
    ds_read_b32 v107, v97
    ds_read2_b32 v[100:101], v98 offset0:0 offset1:2
    ds_read2_b32 v[102:103], v99 offset0:0 offset1:2
    ds_read2_b32 v[104:105], v99 offset0:4 offset1:6
    s_mov_b64 exec, 1
    ds_add_rtn_u32 v108, v109, v110
    s_mov_b64 exec, -1
    s_waitcnt lgkmcnt(3)
    v_mad_u32_u24 v100, v100, v13, v14
    v_mad_u32_u24 v101, v101, v13, v14
    v_bfe_i32 v83, v107, 16, 1
    ds_read_b64_tr_b16 v[84:85], v100
    ds_read_b64_tr_b16 v[86:87], v101
    ds_read_b64_tr_b16 v[88:89], v100 offset:64
    ds_read_b64_tr_b16 v[90:91], v101 offset:64
    v_and_b32 v80, v83, v8
    v_and_b32 v81, v83, v9
    v_and_or_b32 v80, v107, v12, v80
    v_and_b32 v82, v83, v10
    v_and_b32 v83, v83, v11
    s_waitcnt vmcnt(0)
    ds_read_b64_tr_b16 v[64:65], v21 offset:0
    ds_read_b64_tr_b16 v[66:67], v21 offset:512
    ds_read_b64_tr_b16 v[68:69], v21 offset:2048
    ds_read_b64_tr_b16 v[70:71], v21 offset:2560
    ds_read_b64_tr_b16 v[72:73], v22 offset:0
    ds_read_b64_tr_b16 v[74:75], v22 offset:512
    ds_read_b64_tr_b16 v[76:77], v22 offset:2048
    ds_read_b64_tr_b16 v[78:79], v22 offset:2560
    s_waitcnt lgkmcnt(8)
    v_mfma_f32_32x32x16_f16 v[32:47], v[80:83], v[84:87], 0
    v_mfma_f32_32x32x16_f16 v[48:63], v[80:83], v[88:91], 0
    s_waitcnt lgkmcnt(4)
    v_mfma_f32_32x32x16_f16 v[32:47], v[0:3], v[64:67], v[32:47]
    v_mfma_f32_32x32x16_f16 v[32:47], v[4:7], v[68:71], v[32:47]
    s_waitcnt lgkmcnt(0)
    v_mfma_f32_32x32x16_f16 v[48:63], v[0:3], v[72:75], v[48:63]
    v_mfma_f32_32x32x16_f16 v[48:63], v[4:7], v[76:79], v[48:63]
    s_cmp_ge_u32 s65, s42
    s_mov_b32 s41, s65
    v_readfirstlane_b32 s65, v108
    s_cbranch_scc1 NODMA_16
    s_mov_b32 m0, s43
    v_mad_u32_u24 v102, v102, v23, v15
    buffer_load_dwordx4 v[24:25], s[12:15], 0 idxen offen lds
    s_add_u32 m0, m0, 1024
    v_mad_u32_u24 v103, v103, v23, v15
    buffer_load_dwordx4 v[26:27], s[12:15], 0 idxen offen lds
    s_add_u32 m0, m0, 1024
    v_mad_u32_u24 v104, v104, v23, v15
    buffer_load_dwordx4 v[28:29], s[12:15], 0 idxen offen lds
    s_add_u32 m0, m0, 1024
    v_mad_u32_u24 v105, v105, v23, v15
    buffer_load_dwordx4 v[30:31], s[12:15], 0 idxen offen lds
    s_branch DMAD_17
NODMA_16:
    v_mad_u32_u24 v102, v102, v23, v15
    v_mad_u32_u24 v103, v103, v23, v15
    v_mad_u32_u24 v104, v104, v23, v15
    v_mad_u32_u24 v105, v105, v23, v15
    s_nop 3
DMAD_17:
    s_lshl_b32 s72, s41, 7
    s_lshl_b32 s73, s41, 5
    s_lshl_b32 s63, s65, 7
    v_add_u32 v97, s72, v17
    v_add_u32 v98, s73, v18
    v_add_u32 v99, s73, v19
    v_add_u32 v96, s63, v16
    s_setprio 1
    v_exp_f32 v64, v32
    v_exp_f32 v65, v33
    v_exp_f32 v66, v34
    v_exp_f32 v67, v35
    v_exp_f32 v68, v36
    v_exp_f32 v69, v37
    v_exp_f32 v70, v38
    v_exp_f32 v71, v39
    v_exp_f32 v72, v40
    v_exp_f32 v73, v41
    v_exp_f32 v74, v42
    v_exp_f32 v75, v43
    v_exp_f32 v76, v44
    v_exp_f32 v77, v45
    v_exp_f32 v78, v46
    v_exp_f32 v79, v47
    s_setprio 0
    v_add_f32 v65, 1.0, v65
    v_add_f32 v67, 1.0, v67
    v_add_f32 v69, 1.0, v69
    v_add_f32 v71, 1.0, v71
    v_add_f32 v73, 1.0, v73
    v_add_f32 v75, 1.0, v75
    v_add_f32 v77, 1.0, v77
    v_add_f32 v79, 1.0, v79
    v_fma_f32 v84, v33, v64, v33
    v_fma_f32 v85, v35, v66, v35
    v_fma_f32 v86, v37, v68, v37
    v_fma_f32 v87, v39, v70, v39
    v_fma_f32 v88, v41, v72, v41
    v_fma_f32 v89, v43, v74, v43
    v_fma_f32 v90, v45, v76, v45
    v_fma_f32 v91, v47, v78, v47
    v_fma_f32 v64, v64, v65, v65
    v_fma_f32 v66, v66, v67, v67
    v_fma_f32 v68, v68, v69, v69
    v_fma_f32 v70, v70, v71, v71
    v_fma_f32 v72, v72, v73, v73
    v_fma_f32 v74, v74, v75, v75
    v_fma_f32 v76, v76, v77, v77
    v_fma_f32 v78, v78, v79, v79
    v_fma_f32 v84, v32, v65, v84
    v_fma_f32 v85, v34, v67, v85
    v_fma_f32 v86, v36, v69, v86
    v_fma_f32 v87, v38, v71, v87
    v_fma_f32 v88, v40, v73, v88
    v_fma_f32 v89, v42, v75, v89
    v_fma_f32 v90, v44, v77, v90
    v_fma_f32 v91, v46, v79, v91
    v_mul_f32 v80, v64, v66
    v_mul_f32 v92, v84, v66
    v_mul_f32 v81, v68, v70
    v_mul_f32 v93, v86, v70
    v_mul_f32 v82, v72, v74
    v_mul_f32 v94, v88, v74
    v_mul_f32 v83, v76, v78
    v_mul_f32 v95, v90, v78
    v_fma_f32 v92, v85, v64, v92
    v_fma_f32 v93, v87, v68, v93
    v_fma_f32 v94, v89, v72, v94
    v_fma_f32 v95, v91, v76, v95
    s_setprio 1
    v_exp_f32 v64, v48
    v_exp_f32 v65, v49
    v_exp_f32 v66, v50
    v_exp_f32 v67, v51
    v_exp_f32 v68, v52
    v_exp_f32 v69, v53
    v_exp_f32 v70, v54
    v_exp_f32 v71, v55
    v_exp_f32 v72, v56
    v_exp_f32 v73, v57
    v_exp_f32 v74, v58
    v_exp_f32 v75, v59
    v_exp_f32 v76, v60
    v_exp_f32 v77, v61
    v_exp_f32 v78, v62
    v_exp_f32 v79, v63
    v_rcp_f32 v80, v80
    v_rcp_f32 v81, v81
    v_rcp_f32 v82, v82
    v_rcp_f32 v83, v83
    s_setprio 0
    v_fma_f32 v92, v92, v80, v106
    v_fma_f32 v93, v93, v81, v106
    v_fma_f32 v94, v94, v82, v106
    v_fma_f32 v95, v95, v83, v106
    ds_add_u32 v102, v92
    ds_add_u32 v103, v93
    ds_add_u32 v104, v94
    ds_add_u32 v105, v95
    v_add_f32 v65, 1.0, v65
    v_add_f32 v67, 1.0, v67
    v_add_f32 v69, 1.0, v69
    v_add_f32 v71, 1.0, v71
    v_add_f32 v73, 1.0, v73
    v_add_f32 v75, 1.0, v75
    v_add_f32 v77, 1.0, v77
    v_add_f32 v79, 1.0, v79
    v_fma_f32 v84, v49, v64, v49
    v_fma_f32 v85, v51, v66, v51
    v_fma_f32 v86, v53, v68, v53
    v_fma_f32 v87, v55, v70, v55
    v_fma_f32 v88, v57, v72, v57
    v_fma_f32 v89, v59, v74, v59
    v_fma_f32 v90, v61, v76, v61
    v_fma_f32 v91, v63, v78, v63
    v_fma_f32 v64, v64, v65, v65
    v_fma_f32 v66, v66, v67, v67
    v_fma_f32 v68, v68, v69, v69
    v_fma_f32 v70, v70, v71, v71
    v_fma_f32 v72, v72, v73, v73
    v_fma_f32 v74, v74, v75, v75
    v_fma_f32 v76, v76, v77, v77
    v_fma_f32 v78, v78, v79, v79
    v_fma_f32 v84, v48, v65, v84
    v_fma_f32 v85, v50, v67, v85
    v_fma_f32 v86, v52, v69, v86
    v_fma_f32 v87, v54, v71, v87
    v_fma_f32 v88, v56, v73, v88
    v_fma_f32 v89, v58, v75, v89
    v_fma_f32 v90, v60, v77, v90
    v_fma_f32 v91, v62, v79, v91
    v_mul_f32 v80, v64, v66
    v_mul_f32 v92, v84, v66
    v_mul_f32 v81, v68, v70
    v_mul_f32 v93, v86, v70
    v_mul_f32 v82, v72, v74
    v_mul_f32 v94, v88, v74
    v_mul_f32 v83, v76, v78
    v_mul_f32 v95, v90, v78
    v_fma_f32 v92, v85, v64, v92
    v_fma_f32 v93, v87, v68, v93
    v_fma_f32 v94, v89, v72, v94
    v_fma_f32 v95, v91, v76, v95
    s_setprio 1
    v_rcp_f32 v80, v80
    v_rcp_f32 v81, v81
    v_rcp_f32 v82, v82
    v_rcp_f32 v83, v83
    s_setprio 0
    v_fma_f32 v92, v92, v80, v106
    v_fma_f32 v93, v93, v81, v106
    v_fma_f32 v94, v94, v82, v106
    v_fma_f32 v95, v95, v83, v106
    ds_add_u32 v102, v92 offset:128
    ds_add_u32 v103, v93 offset:128
    ds_add_u32 v104, v94 offset:128
    ds_add_u32 v105, v95 offset:128
    s_cmp_lt_u32 s41, s42
    s_cbranch_scc1 ML_F
ML_END_F:
    s_branch K2_EPI
K2_SLOW:
    v_mbcnt_lo_u32_b32 v33, -1, 0
    v_mbcnt_hi_u32_b32 v33, -1, v33
    s_cmp_ge_u32 s40, 2
    s_cbranch_scc0 SQ_18
    s_lshr_b32 s63, s40, 1
    s_sub_u32 s63, s63, 1
    s_lshl_b32 s63, s63, 5
    v_and_b32 v120, 31, v33
    v_add_u32 v120, s63, v120
    s_mul_i32 s72, s2, 196
    v_add_u32 v121, s72, v120
    v_lshlrev_b32 v121, 7, v121
    v_lshrrev_b32 v122, 5, v33
    v_lshl_add_u32 v121, v122, 4, v121
    buffer_load_dwordx4 v[72:75], v121, s[16:19], 0 offen offset:0
    buffer_load_dwordx4 v[76:79], v121, s[16:19], 0 offen offset:32
    buffer_load_dwordx4 v[80:83], v121, s[16:19], 0 offen offset:64
    buffer_load_dwordx4 v[84:87], v121, s[16:19], 0 offen offset:96
    v_lshlrev_b32 v123, 4, v33
    s_and_b32 s63, s40, 1
    s_lshl_b32 s63, s63, 12
    s_add_u32 s63, s63, 8192
    buffer_load_dwordx4 v[88:91], v123, s[36:39], s63 offen offset:0
    buffer_load_dwordx4 v[92:95], v123, s[36:39], s63 offen offset:1024
    buffer_load_dwordx4 v[96:99], v123, s[36:39], s63 offen offset:2048
    buffer_load_dwordx4 v[100:103], v123, s[36:39], s63 offen offset:3072
    v_mov_b32 v124, 0xbfb8aa3b
    s_waitcnt vmcnt(0)
    v_mfma_f32_32x32x16_bf16 v[104:119], v[88:91], v[72:75], 0
    v_mfma_f32_32x32x16_bf16 v[104:119], v[92:95], v[76:79], v[104:119]
    v_mfma_f32_32x32x16_bf16 v[104:119], v[96:99], v[80:83], v[104:119]
    v_mfma_f32_32x32x16_bf16 v[104:119], v[100:103], v[84:87], v[104:119]
    s_nop 11
    v_mul_f32 v104, v124, v104
    v_mul_f32 v105, v124, v105
    v_mul_f32 v106, v124, v106
    v_mul_f32 v107, v124, v107
    v_mul_f32 v108, v124, v108
    v_mul_f32 v109, v124, v109
    v_mul_f32 v110, v124, v110
    v_mul_f32 v111, v124, v111
    v_mul_f32 v112, v124, v112
    v_mul_f32 v113, v124, v113
    v_mul_f32 v114, v124, v114
    v_mul_f32 v115, v124, v115
    v_mul_f32 v116, v124, v116
    v_mul_f32 v117, v124, v117
    v_mul_f32 v118, v124, v118
    v_mul_f32 v119, v124, v119
    v_cvt_pk_bf16_f32 v88, v104, v105
    v_cvt_pk_bf16_f32 v89, v106, v107
    v_cvt_pk_bf16_f32 v90, v108, v109
    v_cvt_pk_bf16_f32 v91, v110, v111
    v_cvt_pk_bf16_f32 v92, v112, v113
    v_cvt_pk_bf16_f32 v93, v114, v115
    v_cvt_pk_bf16_f32 v94, v116, v117
    v_cvt_pk_bf16_f32 v95, v118, v119
    v_cmp_gt_u32 vcc, 196, v120
    v_lshlrev_b32 v120, 7, v120
    v_lshl_add_u32 v120, v122, 5, v120
    s_and_b32 s63, s40, 1
    s_lshl_b32 s63, s63, 6
    s_add_u32 s63, s63, 138624
    v_add_u32 v120, s63, v120
    s_and_b64 exec, exec, vcc
    ds_write_b128 v120, v[88:91]
    ds_write_b128 v120, v[92:95] offset:16
    s_mov_b64 exec, -1
    s_branch SQ_19
SQ_18:
    s_cmp_eq_u32 s40, 0
    s_cbranch_scc0 SQ_19
    v_lshlrev_b32 v120, 1, v33
    s_mov_b32 s63, 32768
    buffer_load_ushort v121, v120, s[36:39], s63 offen offset:128
    v_add_u32 v120, 163712, v120
    s_waitcnt vmcnt(0)
    ds_write_b16 v120, v121
SQ_19:
    s_mov_b32 s76, s4
    s_and_b32 s77, s5, 0xffff
    s_or_b32 s77, s77, 8388608
    s_mov_b32 s78, 50000
    s_mov_b32 s79, 0x20000
    v_lshlrev_b32 v120, 4, v33
    s_movk_i32 s63, 4096
    buffer_load_dwordx4 v[0:3], v120, s[36:39], 0 offen offset:0
    buffer_load_dwordx4 v[4:7], v120, s[36:39], 0 offen offset:1024
    buffer_load_dwordx4 v[8:11], v120, s[36:39], 0 offen offset:2048
    buffer_load_dwordx4 v[12:15], v120, s[36:39], 0 offen offset:3072
    buffer_load_dwordx4 v[16:19], v120, s[36:39], s63 offen offset:0
    buffer_load_dwordx4 v[20:23], v120, s[36:39], s63 offen offset:1024
    buffer_load_dwordx4 v[24:27], v120, s[36:39], s63 offen offset:2048
    buffer_load_dwordx4 v[28:31], v120, s[36:39], s63 offen offset:3072
    s_mov_b32 s60, 0
    s_mov_b32 s69, 16
K2_SLOW_ROUND:
    s_waitcnt vmcnt(0) lgkmcnt(0)
    s_barrier
    v_mbcnt_lo_u32_b32 v33, -1, 0
    v_mbcnt_hi_u32_b32 v33, -1, v33
    s_lshl_b32 s63, s40, 6
    v_add_u32 v32, s63, v33
    v_lshrrev_b32 v120, 3, v32
    v_lshlrev_b32 v120, 10, v120
    s_lshl_b32 s3, s2, 2
    v_add_u32 v120, s3, v120
    buffer_load_dword v34, v120, s[28:31], 0 offen
    v_lshlrev_b32 v116, 4, v32
    v_mov_b32 v112, 0
    v_mov_b32 v113, 0
    v_mov_b32 v114, 0
    v_mov_b32 v115, 0
    v_cmp_gt_u32 vcc, 192, v32
    s_and_b64 exec, exec, vcc
    ds_write_b128 v116, v[112:115] offset:19504
    s_mov_b64 exec, -1
    v_mov_b32 v112, 0xffff
    v_mov_b32 v113, 0xffff
    v_mov_b32 v114, 0xffff
    v_mov_b32 v115, 0xffff
    v_cmp_gt_u32 vcc, 928, v32
    s_and_b64 exec, exec, vcc
    ds_write_b128 v116, v[112:115] offset:4656
    v_cmp_gt_u32 vcc, 232, v32
    s_and_b64 exec, exec, vcc
    v_mov_b32 v112, 784
    v_mov_b32 v113, 784
    v_mov_b32 v114, 784
    v_mov_b32 v115, 784
    ds_write_b128 v116, v[112:115] offset:0
    s_mov_b64 exec, -1
    v_mov_b32 v118, 1
    v_mov_b32 v119, 2
    s_waitcnt vmcnt(0)
    v_lshrrev_b32 v120, 3, v32
    s_movk_i32 s63, 6400
    v_and_b32 v121, 0xffff, v34
    v_mad_u32_u24 v120, v120, s63, v121
    v_add_u32 v120, s60, v120
    v_and_b32 v121, 7, v32
    v_lshl_add_u32 v122, v121, 2, v120
    v_lshl_add_u32 v123, v121, 1, v120
    s_mov_b32 s63, 3276800
    buffer_load_dword v44, v122, s[20:23], s63 offen
    v_lshlrev_b32 v122, 2, v122
    buffer_load_dwordx4 v[36:39], v122, s[20:23], 0 offen
    v_lshrrev_b32 v120, 16, v34
    v_subrev_u32 v120, s60, v120
    v_min_i32 v120, s69, v120
    v_lshlrev_b32 v122, 2, v121
    v_sub_u32 v122, v120, v122
    v_cmp_lt_i32 s[44:45], 0, v122
    v_cmp_lt_i32 s[46:47], 1, v122
    v_cmp_lt_i32 s[48:49], 2, v122
    v_cmp_lt_i32 s[50:51], 3, v122
    v_lshlrev_b32 v121, 1, v121
    v_sub_u32 v121, v120, v121
    v_cmp_lt_i32 s[52:53], 32, v121
    v_cmp_lt_i32 s[54:55], 33, v121
    v_cmp_lt_i32 s[56:57], 48, v121
    v_cmp_lt_i32 s[58:59], 49, v121
    s_waitcnt vmcnt(0) lgkmcnt(0)
    s_barrier
    v_lshlrev_b32_sdwa v48, v119, v44 dst_sel:DWORD dst_unused:UNUSED_PAD src0_sel:DWORD src1_sel:BYTE_0
    v_lshlrev_b32_sdwa v49, v119, v44 dst_sel:DWORD dst_unused:UNUSED_PAD src0_sel:DWORD src1_sel:BYTE_1
    v_lshlrev_b32_sdwa v50, v119, v44 dst_sel:DWORD dst_unused:UNUSED_PAD src0_sel:DWORD src1_sel:BYTE_2
    v_lshlrev_b32_sdwa v51, v119, v44 dst_sel:DWORD dst_unused:UNUSED_PAD src0_sel:DWORD src1_sel:BYTE_3
    s_mov_b64 exec, s[44:45]
    ds_add_rtn_u32 v56, v48, v118 offset:19504
    s_mov_b64 exec, s[46:47]
    ds_add_rtn_u32 v57, v49, v118 offset:19504
    s_mov_b64 exec, s[48:49]
    ds_add_rtn_u32 v58, v50, v118 offset:19504
    s_mov_b64 exec, s[50:51]
    ds_add_rtn_u32 v59, v51, v118 offset:19504
    s_mov_b64 exec, -1
    s_waitcnt lgkmcnt(0)
    s_barrier
    v_lshlrev_b32 v80, 4, v33
    ds_read_b128 v[72:75], v80 offset:19504
    s_waitcnt lgkmcnt(0)
    v_max_u32 v81, v72, v73
    v_max3_u32 v81, v81, v74, v75
    v_add_u32 v72, 3, v72
    v_add_u32 v73, 3, v73
    v_add_u32 v74, 3, v74
    v_add_u32 v75, 3, v75
    v_and_b32 v72, -4, v72
    v_and_b32 v73, -4, v73
    v_and_b32 v74, -4, v74
    v_and_b32 v75, -4, v75
    v_add_u32 v82, v72, v73
    v_add_u32 v83, v74, v75
    v_add_u32 v82, v82, v83
    v_mov_b32 v83, v82
    s_nop 1
    v_add_u32_dpp v83, v83, v83 row_shr:1 row_mask:0xf bank_mask:0xf
    s_nop 1
    v_add_u32_dpp v83, v83, v83 row_shr:2 row_mask:0xf bank_mask:0xf
    s_nop 1
    v_add_u32_dpp v83, v83, v83 row_shr:4 row_mask:0xf bank_mask:0xf
    s_nop 1
    v_add_u32_dpp v83, v83, v83 row_shr:8 row_mask:0xf bank_mask:0xf
    s_nop 1
    v_add_u32_dpp v83, v83, v83 row_bcast:15 row_mask:0xa bank_mask:0xf
    s_nop 1
    v_add_u32_dpp v83, v83, v83 row_bcast:31 row_mask:0xc bank_mask:0xf
    v_sub_u32 v76, v83, v82
    v_add_u32 v77, v76, v72
    v_add_u32 v78, v77, v73
    v_add_u32 v79, v78, v74
    ds_write_b128 v80, v[76:79] offset:20528
    v_readlane_b32 s72, v83, 63
    s_movk_i32 s63, 1020
    v_cmp_lt_u32 vcc, s63, v81
    s_add_u32 s42, s72, 31
    s_lshr_b32 s42, s42, 5
    s_waitcnt lgkmcnt(0)
    ds_read_b32 v64, v48 offset:20528
    ds_read_b32 v65, v49 offset:20528
    ds_read_b32 v66, v50 offset:20528
    ds_read_b32 v67, v51 offset:20528
    s_waitcnt lgkmcnt(0)
    v_add_u32 v56, v64, v56
    v_add_u32 v57, v65, v57
    v_add_u32 v58, v66, v58
    v_add_u32 v59, v67, v59
    v_lshlrev_b32 v64, 2, v56
    v_and_b32 v56, -4, v56
    v_lshlrev_b32 v65, 2, v57
    v_and_b32 v57, -4, v57
    v_lshlrev_b32 v66, 2, v58
    v_and_b32 v58, -4, v58
    v_lshlrev_b32 v67, 2, v59
    v_and_b32 v59, -4, v59
    s_mov_b64 exec, s[44:45]
    ds_write_b32 v64, v36 offset:4656
    ds_write_b32 v56, v48 offset:0
    s_mov_b64 exec, s[46:47]
    ds_write_b32 v65, v37 offset:4656
    ds_write_b32 v57, v49 offset:0
    s_mov_b64 exec, s[48:49]
    ds_write_b32 v66, v38 offset:4656
    ds_write_b32 v58, v50 offset:0
    s_mov_b64 exec, s[50:51]
    ds_write_b32 v67, v39 offset:4656
    ds_write_b32 v59, v51 offset:0
    s_mov_b64 exec, -1
    v_mov_b32 v127, v33
    v_lshrrev_b32 v64, 4, v127
    v_and_b32 v65, 7, v127
    v_xor_b32 v64, v64, v65
    v_lshlrev_b32 v97, 4, v64
    v_mov_b32 v101, v97
    v_xor_b32 v99, 64, v97
    v_mov_b32 v103, v99
    v_lshrrev_b32 v64, 3, v127
    s_lshl_b32 s63, s40, 7
    s_add_u32 s63, s63, 4656
    v_lshl_add_u32 v109, v64, 2, s63
    v_and_b32 v66, 31, v127
    v_lshrrev_b32 v67, 5, v127
    v_lshl_add_u32 v110, v66, 2, s63
    v_bfe_u32 v68, v66, 1, 3
    v_xor_b32 v68, v68, v67
    v_lshlrev_b32 v68, 4, v68
    v_lshl_add_u32 v69, v66, 7, s43
    v_xor_b32 v70, 0, v68
    v_add_u32 v123, v69, v70
    v_xor_b32 v70, 32, v68
    v_add_u32 v124, v69, v70
    v_xor_b32 v70, 64, v68
    v_add_u32 v125, v69, v70
    v_xor_b32 v70, 96, v68
    v_add_u32 v126, v69, v70
    v_lshrrev_b32 v68, 2, v66
    v_lshlrev_b32 v69, 2, v67
    v_sub_u32 v68, v68, v69
    v_cmp_eq_u32 s[74:75], 0, v68
    v_mov_b32 v69, 0x3f80
    s_nop 0
    v_cndmask_b32 v104, 0, v69, s[74:75]
    v_cmp_eq_u32 s[74:75], 1, v68
    v_mov_b32 v69, 0x3f80
    s_nop 0
    v_cndmask_b32 v105, 0, v69, s[74:75]
    v_cmp_eq_u32 s[74:75], 2, v68
    v_mov_b32 v69, 0x3f80
    s_nop 0
    v_cndmask_b32 v106, 0, v69, s[74:75]
    v_cmp_eq_u32 s[74:75], 3, v68
    v_mov_b32 v69, 0x3f80
    s_nop 0
    v_cndmask_b32 v107, 0, v69, s[74:75]
    v_cmp_eq_u32 s[74:75], 0, v67
    v_mov_b32 v69, 0xffff0000
    s_nop 0
    v_cndmask_b32 v108, 0, v69, s[74:75]
    v_bfe_u32 v68, v127, 2, 2
    v_lshrrev_b32 v69, 1, v68
    v_lshl_add_u32 v69, v67, 2, v69
    s_lshl_b32 s63, s40, 5
    v_lshl_add_u32 v111, v69, 2, s63
    v_lshl_add_u32 v112, v67, 2, s63
    v_and_b32 v69, 1, v68
    v_xor_b32 v113, 1, v69
    v_lshlrev_b32 v113, 5, v113
    v_bfe_u32 v70, v127, 4, 1
    v_lshlrev_b32 v70, 5, v70
    v_and_b32 v71, 3, v127
    v_lshl_add_u32 v70, v71, 3, v70
    v_add_u32 v70, 138624, v70
    s_mov_b32 s63, 25088
    v_mad_u32_u24 v120, v69, s63, v70
    v_lshlrev_b32 v121, 2, v66
    v_add_u32 v121, 85040, v121
    v_mov_b32 v122, 68
    s_waitcnt lgkmcnt(0)
    s_barrier
    s_mov_b32 s41, s40
    s_cmp_ge_u32 s41, s42
    s_cbranch_scc1 ML_END_S
    ds_read_u16 v96, v109 offset:0
    ds_read_u16 v98, v109 offset:32
    ds_read_u16 v100, v109 offset:64
    ds_read_u16 v102, v109 offset:96
    s_waitcnt lgkmcnt(0)
    s_mov_b32 m0, s43
    v_add_u32 v109, 2048, v109
    buffer_load_dwordx4 v[96:97], s[76:79], 0 idxen offen lds
    s_add_u32 m0, m0, 1024
    s_nop 0
    buffer_load_dwordx4 v[98:99], s[76:79], 0 idxen offen lds
    s_add_u32 m0, m0, 1024
    s_nop 0
    buffer_load_dwordx4 v[100:101], s[76:79], 0 idxen offen lds
    s_add_u32 m0, m0, 1024
    s_nop 0
    buffer_load_dwordx4 v[102:103], s[76:79], 0 idxen offen lds
ML_S:
    ds_read_u16 v96, v109 offset:0
    ds_read_u16 v98, v109 offset:32
    ds_read_u16 v100, v109 offset:64
    ds_read_u16 v102, v109 offset:96
    ds_read_b32 v127, v110
    ds_read2_b32 v[114:115], v111 offset0:0 offset1:2
    ds_read2_b32 v[116:117], v112 offset0:0 offset1:2
    ds_read2_b32 v[118:119], v112 offset0:4 offset1:6
    s_waitcnt vmcnt(0)
    ds_read_b128 v[64:67], v123
    ds_read_b128 v[68:71], v124
    ds_read_b128 v[72:75], v125
    ds_read_b128 v[76:79], v126
    s_waitcnt lgkmcnt(0)
    v_mad_u32_u24 v114, v114, v113, v120
    v_mad_u32_u24 v115, v115, v113, v120
    v_and_b32 v83, 0xffff, v127
    v_mov_b32 v82, 0xffff
    v_cmp_ne_u32 s[74:75], v83, v82
    s_nop 1
    v_cndmask_b32 v83, 0, -1, s[74:75]
    v_and_b32 v80, v83, v104
    v_and_b32 v81, v83, v105
    v_and_or_b32 v80, v127, v108, v80
    v_and_b32 v82, v83, v106
    v_and_b32 v83, v83, v107
    ds_read_b64_tr_b16 v[84:85], v114
    ds_read_b64_tr_b16 v[86:87], v115
    ds_read_b64_tr_b16 v[88:89], v114 offset:64
    ds_read_b64_tr_b16 v[90:91], v115 offset:64
    s_waitcnt lgkmcnt(0)
    v_mfma_f32_32x32x16_bf16 v[32:47], v[80:83], v[84:87], 0
    v_mfma_f32_32x32x16_bf16 v[32:47], v[64:67], v[0:3], v[32:47]
    v_mfma_f32_32x32x16_bf16 v[32:47], v[68:71], v[8:11], v[32:47]
    v_mfma_f32_32x32x16_bf16 v[32:47], v[72:75], v[16:19], v[32:47]
    v_mfma_f32_32x32x16_bf16 v[32:47], v[76:79], v[24:27], v[32:47]
    v_mfma_f32_32x32x16_bf16 v[48:63], v[80:83], v[88:91], 0
    v_mfma_f32_32x32x16_bf16 v[48:63], v[64:67], v[4:7], v[48:63]
    v_mfma_f32_32x32x16_bf16 v[48:63], v[68:71], v[12:15], v[48:63]
    v_mfma_f32_32x32x16_bf16 v[48:63], v[72:75], v[20:23], v[48:63]
    v_mfma_f32_32x32x16_bf16 v[48:63], v[76:79], v[28:31], v[48:63]
    s_add_u32 s41, s41, 16
    s_cmp_ge_u32 s41, s42
    s_cbranch_scc1 NODMA_20
    s_mov_b32 m0, s43
    v_mad_u32_u24 v116, v116, v122, v121
    buffer_load_dwordx4 v[96:97], s[76:79], 0 idxen offen lds
    s_add_u32 m0, m0, 1024
    v_mad_u32_u24 v117, v117, v122, v121
    buffer_load_dwordx4 v[98:99], s[76:79], 0 idxen offen lds
    s_add_u32 m0, m0, 1024
    v_mad_u32_u24 v118, v118, v122, v121
    buffer_load_dwordx4 v[100:101], s[76:79], 0 idxen offen lds
    s_add_u32 m0, m0, 1024
    v_mad_u32_u24 v119, v119, v122, v121
    buffer_load_dwordx4 v[102:103], s[76:79], 0 idxen offen lds
    v_add_u32 v109, 2048, v109
    v_add_u32 v110, 2048, v110
    v_add_u32 v111, 512, v111
    v_add_u32 v112, 512, v112
    s_branch DMAD_21
NODMA_20:
    v_mad_u32_u24 v116, v116, v122, v121
    v_mad_u32_u24 v117, v117, v122, v121
    v_mad_u32_u24 v118, v118, v122, v121
    v_mad_u32_u24 v119, v119, v122, v121
    v_add_u32 v109, 2048, v109
    v_add_u32 v110, 2048, v110
    v_add_u32 v111, 512, v111
    v_add_u32 v112, 512, v112
DMAD_21:
    s_nop 7
    s_nop 3
    v_exp_f32 v64, v32
    v_exp_f32 v65, v33
    v_exp_f32 v66, v34
    v_exp_f32 v67, v35
    v_exp_f32 v68, v36
    v_exp_f32 v69, v37
    v_exp_f32 v70, v38
    v_exp_f32 v71, v39
    v_exp_f32 v72, v40
    v_exp_f32 v73, v41
    v_exp_f32 v74, v42
    v_exp_f32 v75, v43
    v_exp_f32 v76, v44
    v_exp_f32 v77, v45
    v_exp_f32 v78, v46
    v_exp_f32 v79, v47
    s_nop 0
    v_add_f32 v64, 1.0, v64
    v_add_f32 v65, 1.0, v65
    v_add_f32 v66, 1.0, v66
    v_add_f32 v67, 1.0, v67
    v_add_f32 v68, 1.0, v68
    v_add_f32 v69, 1.0, v69
    v_add_f32 v70, 1.0, v70
    v_add_f32 v71, 1.0, v71
    v_add_f32 v72, 1.0, v72
    v_add_f32 v73, 1.0, v73
    v_add_f32 v74, 1.0, v74
    v_add_f32 v75, 1.0, v75
    v_add_f32 v76, 1.0, v76
    v_add_f32 v77, 1.0, v77
    v_add_f32 v78, 1.0, v78
    v_add_f32 v79, 1.0, v79
    v_rcp_f32 v64, v64
    v_rcp_f32 v65, v65
    v_rcp_f32 v66, v66
    v_rcp_f32 v67, v67
    v_rcp_f32 v68, v68
    v_rcp_f32 v69, v69
    v_rcp_f32 v70, v70
    v_rcp_f32 v71, v71
    v_rcp_f32 v72, v72
    v_rcp_f32 v73, v73
    v_rcp_f32 v74, v74
    v_rcp_f32 v75, v75
    v_rcp_f32 v76, v76
    v_rcp_f32 v77, v77
    v_rcp_f32 v78, v78
    v_rcp_f32 v79, v79
    s_nop 0
    v_mul_f32 v92, v32, v64
    v_mul_f32 v93, v36, v68
    v_mul_f32 v94, v40, v72
    v_mul_f32 v95, v44, v76
    v_fmac_f32 v92, v33, v65
    v_fmac_f32 v93, v37, v69
    v_fmac_f32 v94, v41, v73
    v_fmac_f32 v95, v45, v77
    v_fmac_f32 v92, v34, v66
    v_fmac_f32 v93, v38, v70
    v_fmac_f32 v94, v42, v74
    v_fmac_f32 v95, v46, v78
    v_fmac_f32 v92, v35, v67
    v_fmac_f32 v93, v39, v71
    v_fmac_f32 v94, v43, v75
    v_fmac_f32 v95, v47, v79
    ds_add_f32 v116, v92 offset:0
    ds_add_f32 v117, v93 offset:0
    ds_add_f32 v118, v94 offset:0
    ds_add_f32 v119, v95 offset:0
    v_exp_f32 v64, v48
    v_exp_f32 v65, v49
    v_exp_f32 v66, v50
    v_exp_f32 v67, v51
    v_exp_f32 v68, v52
    v_exp_f32 v69, v53
    v_exp_f32 v70, v54
    v_exp_f32 v71, v55
    v_exp_f32 v72, v56
    v_exp_f32 v73, v57
    v_exp_f32 v74, v58
    v_exp_f32 v75, v59
    v_exp_f32 v76, v60
    v_exp_f32 v77, v61
    v_exp_f32 v78, v62
    v_exp_f32 v79, v63
    s_nop 0
    v_add_f32 v64, 1.0, v64
    v_add_f32 v65, 1.0, v65
    v_add_f32 v66, 1.0, v66
    v_add_f32 v67, 1.0, v67
    v_add_f32 v68, 1.0, v68
    v_add_f32 v69, 1.0, v69
    v_add_f32 v70, 1.0, v70
    v_add_f32 v71, 1.0, v71
    v_add_f32 v72, 1.0, v72
    v_add_f32 v73, 1.0, v73
    v_add_f32 v74, 1.0, v74
    v_add_f32 v75, 1.0, v75
    v_add_f32 v76, 1.0, v76
    v_add_f32 v77, 1.0, v77
    v_add_f32 v78, 1.0, v78
    v_add_f32 v79, 1.0, v79
    v_rcp_f32 v64, v64
    v_rcp_f32 v65, v65
    v_rcp_f32 v66, v66
    v_rcp_f32 v67, v67
    v_rcp_f32 v68, v68
    v_rcp_f32 v69, v69
    v_rcp_f32 v70, v70
    v_rcp_f32 v71, v71
    v_rcp_f32 v72, v72
    v_rcp_f32 v73, v73
    v_rcp_f32 v74, v74
    v_rcp_f32 v75, v75
    v_rcp_f32 v76, v76
    v_rcp_f32 v77, v77
    v_rcp_f32 v78, v78
    v_rcp_f32 v79, v79
    s_nop 0
    v_mul_f32 v92, v48, v64
    v_mul_f32 v93, v52, v68
    v_mul_f32 v94, v56, v72
    v_mul_f32 v95, v60, v76
    v_fmac_f32 v92, v49, v65
    v_fmac_f32 v93, v53, v69
    v_fmac_f32 v94, v57, v73
    v_fmac_f32 v95, v61, v77
    v_fmac_f32 v92, v50, v66
    v_fmac_f32 v93, v54, v70
    v_fmac_f32 v94, v58, v74
    v_fmac_f32 v95, v62, v78
    v_fmac_f32 v92, v51, v67
    v_fmac_f32 v93, v55, v71
    v_fmac_f32 v94, v59, v75
    v_fmac_f32 v95, v63, v79
    ds_add_f32 v116, v92 offset:128
    ds_add_f32 v117, v93 offset:128
    ds_add_f32 v118, v94 offset:128
    ds_add_f32 v119, v95 offset:128
    s_cmp_lt_u32 s41, s42
    s_cbranch_scc1 ML_S
ML_END_S:
    s_add_u32 s60, s60, 16
    s_cmp_lt_u32 s60, s62
    s_cbranch_scc1 K2_SLOW_ROUND
K2_EPI:
    s_cmp_lt_u32 s40, 13
    s_cbranch_scc0 EL_22
    v_mbcnt_lo_u32_b32 v123, -1, 0
    v_mbcnt_hi_u32_b32 v123, -1, v123
    s_lshl_b32 s63, s40, 4
    v_and_b32 v118, 15, v123
    v_add_u32 v118, s63, v118
    s_mul_i32 s72, s2, 196
    v_add_u32 v115, s72, v118
    v_lshlrev_b32 v115, 7, v115
    v_lshrrev_b32 v120, 4, v123
    v_lshl_add_u32 v115, v120, 4, v115
    buffer_load_dwordx4 v[64:67], v115, s[16:19], 0 offen offset:0
    buffer_load_dwordx4 v[68:71], v115, s[16:19], 0 offen offset:64
    v_lshlrev_b32 v117, 4, v123
    s_mov_b32 s63, 16384
    buffer_load_dwordx4 v[0:3], v117, s[36:39], s63 offen offset:0
    buffer_load_dwordx4 v[4:7], v117, s[36:39], s63 offen offset:1024
    buffer_load_dwordx4 v[8:11], v117, s[36:39], s63 offen offset:2048
    buffer_load_dwordx4 v[12:15], v117, s[36:39], s63 offen offset:3072
    s_add_u32 s63, s63, 4096
    buffer_load_dwordx4 v[16:19], v117, s[36:39], s63 offen offset:0
    buffer_load_dwordx4 v[20:23], v117, s[36:39], s63 offen offset:1024
    buffer_load_dwordx4 v[24:27], v117, s[36:39], s63 offen offset:2048
    buffer_load_dwordx4 v[28:31], v117, s[36:39], s63 offen offset:3072
    s_add_u32 s63, s63, 4096
    buffer_load_dwordx4 v[32:35], v117, s[36:39], s63 offen offset:0
    buffer_load_dwordx4 v[36:39], v117, s[36:39], s63 offen offset:1024
    buffer_load_dwordx4 v[40:43], v117, s[36:39], s63 offen offset:2048
    buffer_load_dwordx4 v[44:47], v117, s[36:39], s63 offen offset:3072
    s_add_u32 s63, s63, 4096
    buffer_load_dwordx4 v[48:51], v117, s[36:39], s63 offen offset:0
    buffer_load_dwordx4 v[52:55], v117, s[36:39], s63 offen offset:1024
    buffer_load_dwordx4 v[56:59], v117, s[36:39], s63 offen offset:2048
    buffer_load_dwordx4 v[60:63], v117, s[36:39], s63 offen offset:3072
EL_22:
    s_cmp_lt_u32 s40, 13
    s_cbranch_scc0 K2_EPI_IDLE
    v_min_u32 v122, 196, v118
    v_lshlrev_b32 v124, 2, v122
    s_movk_i32 s63, 272
    v_mul_u32_u24 v122, s63, v122
    v_add_u32 v122, 85040, v122
    v_lshl_add_u32 v119, v120, 5, v122
    v_lshrrev_b32 v112, 3, v123
    s_lshl_b32 s72, s40, 4
    v_add_u32 v112, s72, v112
    v_and_b32 v113, 7, v123
    v_lshlrev_b32 v113, 4, v113
    v_min_u32 v114, 196, v112
    v_add_u32 v126, 8, v112
    v_min_u32 v126, 196, v126
    v_mad_u32_u24 v114, v114, s63, v113
    v_add_u32 v114, 85040, v114
    v_mad_u32_u24 v126, v126, s63, v113
    v_add_u32 v126, 85040, v126
    s_mul_i32 s72, s2, 196
    v_add_u32 v115, s72, v112
    v_lshl_add_u32 v115, v115, 7, v113
    s_waitcnt lgkmcnt(0)
    s_barrier
    ds_read_b32 v124, v124 offset:3712
    ds_read_b128 v[80:83], v119 offset:0
    ds_read_b128 v[84:87], v119 offset:16
    ds_read_b128 v[88:91], v119 offset:128
    ds_read_b128 v[92:95], v119 offset:144
    s_cmp_eq_u32 s68, 0
    s_cbranch_scc1 EPS_23
    v_mov_b32 v116, s67
    s_waitcnt lgkmcnt(4)
    v_mul_lo_u32 v124, v124, s66
    s_waitcnt lgkmcnt(0)
    v_sub_u32 v80, v80, v124
    v_sub_u32 v81, v81, v124
    v_sub_u32 v82, v82, v124
    v_sub_u32 v83, v83, v124
    v_sub_u32 v84, v84, v124
    v_sub_u32 v85, v85, v124
    v_sub_u32 v86, v86, v124
    v_sub_u32 v87, v87, v124
    v_sub_u32 v88, v88, v124
    v_sub_u32 v89, v89, v124
    v_sub_u32 v90, v90, v124
    v_sub_u32 v91, v91, v124
    v_sub_u32 v92, v92, v124
    v_sub_u32 v93, v93, v124
    v_sub_u32 v94, v94, v124
    v_sub_u32 v95, v95, v124
    v_cvt_f32_i32 v80, v80
    v_cvt_f32_i32 v81, v81
    v_cvt_f32_i32 v82, v82
    v_cvt_f32_i32 v83, v83
    v_cvt_f32_i32 v84, v84
    v_cvt_f32_i32 v85, v85
    v_cvt_f32_i32 v86, v86
    v_cvt_f32_i32 v87, v87
    v_cvt_f32_i32 v88, v88
    v_cvt_f32_i32 v89, v89
    v_cvt_f32_i32 v90, v90
    v_cvt_f32_i32 v91, v91
    v_cvt_f32_i32 v92, v92
    v_cvt_f32_i32 v93, v93
    v_cvt_f32_i32 v94, v94
    v_cvt_f32_i32 v95, v95
    s_branch EPD_24
EPS_23:
    v_mov_b32 v116, 0xbf317218
    s_waitcnt lgkmcnt(0)
EPD_24:
    v_mov_b32 v117, v116
    v_pk_mul_f32 v[80:81], v[80:81], v[116:117]
    v_pk_mul_f32 v[82:83], v[82:83], v[116:117]
    v_pk_mul_f32 v[84:85], v[84:85], v[116:117]
    v_pk_mul_f32 v[86:87], v[86:87], v[116:117]
    v_pk_mul_f32 v[88:89], v[88:89], v[116:117]
    v_pk_mul_f32 v[90:91], v[90:91], v[116:117]
    v_pk_mul_f32 v[92:93], v[92:93], v[116:117]
    v_pk_mul_f32 v[94:95], v[94:95], v[116:117]
    v_cvt_pk_bf16_f32 v72, v80, v81
    v_cvt_pk_bf16_f32 v73, v82, v83
    v_cvt_pk_bf16_f32 v74, v84, v85
    v_cvt_pk_bf16_f32 v75, v86, v87
    v_cvt_pk_bf16_f32 v76, v88, v89
    v_cvt_pk_bf16_f32 v77, v90, v91
    v_cvt_pk_bf16_f32 v78, v92, v93
    v_cvt_pk_bf16_f32 v79, v94, v95
    v_mov_b32 v116, 0xbfb8aa3b
    v_mov_b32 v117, v116
    s_waitcnt vmcnt(0)
    v_mfma_f32_16x16x32_bf16 v[96:99], v[0:3], v[64:67], 0
    v_mfma_f32_16x16x32_bf16 v[96:99], v[4:7], v[68:71], v[96:99]
    v_mfma_f32_16x16x32_bf16 v[96:99], v[8:11], v[72:75], v[96:99]
    v_mfma_f32_16x16x32_bf16 v[96:99], v[12:15], v[76:79], v[96:99]
    v_mfma_f32_16x16x32_bf16 v[100:103], v[16:19], v[64:67], 0
    v_mfma_f32_16x16x32_bf16 v[100:103], v[20:23], v[68:71], v[100:103]
    v_mfma_f32_16x16x32_bf16 v[100:103], v[24:27], v[72:75], v[100:103]
    v_mfma_f32_16x16x32_bf16 v[100:103], v[28:31], v[76:79], v[100:103]
    v_mfma_f32_16x16x32_bf16 v[104:107], v[32:35], v[64:67], 0
    v_mfma_f32_16x16x32_bf16 v[104:107], v[36:39], v[68:71], v[104:107]
    v_mfma_f32_16x16x32_bf16 v[104:107], v[40:43], v[72:75], v[104:107]
    v_mfma_f32_16x16x32_bf16 v[104:107], v[44:47], v[76:79], v[104:107]
    v_mfma_f32_16x16x32_bf16 v[108:111], v[48:51], v[64:67], 0
    v_mfma_f32_16x16x32_bf16 v[108:111], v[52:55], v[68:71], v[108:111]
    v_mfma_f32_16x16x32_bf16 v[108:111], v[56:59], v[72:75], v[108:111]
    v_mfma_f32_16x16x32_bf16 v[108:111], v[60:63], v[76:79], v[108:111]
    s_nop 7
    v_pk_mul_f32 v[80:81], v[96:97], v[116:117]
    v_pk_mul_f32 v[82:83], v[98:99], v[116:117]
    v_pk_mul_f32 v[84:85], v[100:101], v[116:117]
    v_pk_mul_f32 v[86:87], v[102:103], v[116:117]
    v_pk_mul_f32 v[88:89], v[104:105], v[116:117]
    v_pk_mul_f32 v[90:91], v[106:107], v[116:117]
    v_pk_mul_f32 v[92:93], v[108:109], v[116:117]
    v_pk_mul_f32 v[94:95], v[110:111], v[116:117]
    v_exp_f32 v80, v80
    v_exp_f32 v81, v81
    v_exp_f32 v82, v82
    v_exp_f32 v83, v83
    v_exp_f32 v84, v84
    v_exp_f32 v85, v85
    v_exp_f32 v86, v86
    v_exp_f32 v87, v87
    v_exp_f32 v88, v88
    v_exp_f32 v89, v89
    v_exp_f32 v90, v90
    v_exp_f32 v91, v91
    v_exp_f32 v92, v92
    v_exp_f32 v93, v93
    v_exp_f32 v94, v94
    v_exp_f32 v95, v95
    s_nop 0
    v_add_f32 v80, 1.0, v80
    v_add_f32 v81, 1.0, v81
    v_add_f32 v82, 1.0, v82
    v_add_f32 v83, 1.0, v83
    v_add_f32 v84, 1.0, v84
    v_add_f32 v85, 1.0, v85
    v_add_f32 v86, 1.0, v86
    v_add_f32 v87, 1.0, v87
    v_add_f32 v88, 1.0, v88
    v_add_f32 v89, 1.0, v89
    v_add_f32 v90, 1.0, v90
    v_add_f32 v91, 1.0, v91
    v_add_f32 v92, 1.0, v92
    v_add_f32 v93, 1.0, v93
    v_add_f32 v94, 1.0, v94
    v_add_f32 v95, 1.0, v95
    v_rcp_f32 v80, v80
    v_rcp_f32 v81, v81
    v_rcp_f32 v82, v82
    v_rcp_f32 v83, v83
    v_rcp_f32 v84, v84
    v_rcp_f32 v85, v85
    v_rcp_f32 v86, v86
    v_rcp_f32 v87, v87
    v_rcp_f32 v88, v88
    v_rcp_f32 v89, v89
    v_rcp_f32 v90, v90
    v_rcp_f32 v91, v91
    v_rcp_f32 v92, v92
    v_rcp_f32 v93, v93
    v_rcp_f32 v94, v94
    v_rcp_f32 v95, v95
    s_nop 0
    v_pk_mul_f32 v[80:81], v[96:97], v[80:81]
    v_pk_mul_f32 v[82:83], v[98:99], v[82:83]
    v_pk_mul_f32 v[84:85], v[100:101], v[84:85]
    v_pk_mul_f32 v[86:87], v[102:103], v[86:87]
    v_pk_mul_f32 v[88:89], v[104:105], v[88:89]
    v_pk_mul_f32 v[90:91], v[106:107], v[90:91]
    v_pk_mul_f32 v[92:93], v[108:109], v[92:93]
    v_pk_mul_f32 v[94:95], v[110:111], v[94:95]
    v_cvt_pk_bf16_f32 v64, v80, v81
    v_cvt_pk_bf16_f32 v65, v82, v83
    v_cvt_pk_bf16_f32 v66, v84, v85
    v_cvt_pk_bf16_f32 v67, v86, v87
    v_cvt_pk_bf16_f32 v68, v88, v89
    v_cvt_pk_bf16_f32 v69, v90, v91
    v_cvt_pk_bf16_f32 v70, v92, v93
    v_cvt_pk_bf16_f32 v71, v94, v95
    ds_write_b128 v119, v[64:67]
    ds_write_b128 v119, v[68:71] offset:16
    v_cmp_gt_u32 vcc, 196, v112
    s_mov_b64 s[74:75], vcc
    v_cmp_gt_u32 vcc, 188, v112
    s_waitcnt lgkmcnt(0)
    ds_read_b128 v[64:67], v114
    ds_read_b128 v[68:71], v126
    s_mov_b64 exec, s[74:75]
    s_waitcnt lgkmcnt(1)
    buffer_store_dwordx4 v[64:67], v115, s[24:27], 0 offen
    s_mov_b64 exec, vcc
    s_waitcnt lgkmcnt(0)
    buffer_store_dwordx4 v[68:71], v115, s[24:27], 0 offen offset:1024
    s_endpgm
K2_EPI_IDLE:
    s_waitcnt vmcnt(0) lgkmcnt(0)
    s_barrier
K2_END:
    s_endpgm
.section .rodata,"a"
.p2align 6
.amdhsa_kernel k1_kernel
  .amdhsa_next_free_vgpr 128
  .amdhsa_next_free_sgpr 96
  .amdhsa_accum_offset 128
  .amdhsa_group_segment_fixed_size 0
  .amdhsa_kernarg_size 72
  .amdhsa_user_sgpr_count 2
  .amdhsa_user_sgpr_kernarg_segment_ptr 1
  .amdhsa_system_sgpr_workgroup_id_x 1
  .amdhsa_float_denorm_mode_32 3
  .amdhsa_float_denorm_mode_16_64 3
.end_amdhsa_kernel
.p2align 6
.amdhsa_kernel k2_kernel
  .amdhsa_next_free_vgpr 128
  .amdhsa_next_free_sgpr 100
  .amdhsa_accum_offset 128
  .amdhsa_group_segment_fixed_size 0
  .amdhsa_kernarg_size 72
  .amdhsa_user_sgpr_count 2
  .amdhsa_user_sgpr_kernarg_segment_ptr 1
  .amdhsa_system_sgpr_workgroup_id_x 1
  .amdhsa_float_denorm_mode_32 3
  .amdhsa_float_denorm_mode_16_64 3
.end_amdhsa_kernel
```
